```python
import torch

def _softmax(x, axis=-1):
    return torch.softmax(x, dim=axis)
def _gelu(x):
    return torch.nn.functional.gelu(x, approximate="tanh")
def _silu(x):
    return torch.nn.functional.silu(x)
def _sigmoid(x):
    return torch.sigmoid(x)
def _layernorm(x, axis=-1, eps=1e-5):
    m = x.mean(dim=axis, keepdim=True)
    v = x.var(dim=axis, keepdim=True, unbiased=False)
    return (x - m) / torch.sqrt(v + eps)
def _scatter_add(tgt, idx, src, axis=0):
    return tgt.clone().index_add_(axis, idx, src)
def _segment_sum(src, seg, n):
    out = torch.zeros((n,) + src.shape[1:], dtype=src.dtype)
    return out.index_add_(0, seg, src)
def _pad(x, pw):
    flat = tuple(v for pair in reversed(pw) for v in pair)
    return torch.nn.functional.pad(x, flat)

kernel_name = 'standalone__detection_seg_dino__vision'

def setup_inputs():

    _w = (lambda a: (lambda t: t.to(torch.bfloat16) if t.is_floating_point() else t)(torch.as_tensor(a)))
    H = W = (256 // 2) * 2
    C = 384
    Nq = 16
    sc = C ** -0.5
    return {
        "q": _w((lambda *s: torch.randn(*s, dtype=torch.bfloat16) * 0.05)(1, Nq, C)),
        "f0": _w((lambda *s: torch.randn(*s, dtype=torch.bfloat16) * 0.8)(1, H, W, C)),
        "f1": _w((lambda *s: torch.randn(*s, dtype=torch.bfloat16) * 0.8)(1, H // 2, W // 2, C)),
        "wq": _w((lambda *s: torch.randn(*s, dtype=torch.bfloat16) * 1.6)(C, C) * sc),
        "wk": _w((lambda *s: torch.randn(*s, dtype=torch.bfloat16) * 1.6)(C, C) * sc),
        "wv": _w((lambda *s: torch.randn(*s, dtype=torch.bfloat16) * 0.8)(C, C) * sc),
        "wo": _w((lambda *s: torch.randn(*s, dtype=torch.bfloat16) * 0.8)(C, C) * sc),
    }

def reference(q, f0, f1, wq, wk, wv, wo):
    B, H, W, C = f0.shape
    f1u = (lambda x, n, axis: torch.repeat_interleave(x, n, dim=axis))((lambda x, n, axis: torch.repeat_interleave(x, n, dim=axis))(f1, 2, axis=1), 2, axis=2)
    fused = f0 + f1u
    feats = _layernorm(fused.reshape(B, H * W, C), axis=-1)
    qn = _layernorm(q, axis=-1)
    Q = torch.einsum("bnc,cd->bnd", qn, wq)
    K = torch.einsum("bmc,cd->bmd", feats, wk)
    V = torch.einsum("bmc,cd->bmd", feats, wv)
    scale = C ** -0.5
    logits = torch.einsum("bnd,bmd->bnm", Q, K) * scale
    attn = _softmax(logits, axis=-1)
    ctx = torch.einsum("bnm,bmd->bnd", attn, V)
    return q + torch.einsum("bnd,dc->bnc", ctx, wo)
```

```asm
; @launch grid=(256,1,1) block=(512,1,1) lds=163840
.amdgcn_target "amdgcn-amd-amdhsa--gfx950"
.text
.globl standalone__detection_seg_dino__vision_kernel
.p2align 8
.type standalone__detection_seg_dino__vision_kernel,@function
standalone__detection_seg_dino__vision_kernel:
  s_cmp_ge_u32 s2, 256
  s_cbranch_scc1 L_end
  s_load_dwordx16 s[4:19], s[0:1], 0
  s_load_dwordx4 s[20:23], s[0:1], 64
  s_cmp_ge_u32 s2, 32
  s_cbranch_scc1 L_nopf
  s_getpc_b64 s[60:61]
L_pc_1:
  s_sub_u32 s60, s60, L_pc_1-standalone__detection_seg_dino__vision_kernel
  s_subb_u32 s61, s61, 0
  s_bfe_u32 s62, s2, 0x20003
  s_lshl_b32 s62, s62, 13
  v_lshl_add_u32 v246, v0, 4, s62
  v_min_u32 v246, L_code_end-standalone__detection_seg_dino__vision_kernel-16, v246
  global_load_dwordx4 v[168:171], v246, s[60:61]
L_nopf:
  v_lshrrev_b32 v1, 6, v0
  v_and_b32 v0, 63, v0
  v_readfirstlane_b32 s3, v1
  s_mov_b32 s57, 0x00003f80
  s_mov_b32 s58, 0x3f800000
  s_and_b32 s60, s2, 7
  s_lshr_b32 s61, s2, 3
  s_sub_u32 s62, s60, 0
  s_cmp_lt_u32 s61, 24
  s_cbranch_scc0 L_late
  s_cmp_lt_u32 s62, 1
  s_cbranch_scc0 L_early
  s_mul_i32 s56, s61, 1
  s_add_u32 s56, s56, s62
  s_branch L_helper
L_early:
  s_cmp_lt_u32 s60, 0
  s_cselect_b32 s62, 0, 1
  s_sub_u32 s62, s60, s62
  s_mul_i32 s56, s61, 7
  s_add_u32 s56, s56, s62
  s_branch L_stream
L_late:
  s_sub_u32 s56, s2, 24
  s_cmp_eq_u32 s56, 228
  s_cbranch_scc1 L_collect
  s_cmp_ge_u32 s56, 228
  s_cbranch_scc1 L_end
L_stream:
  s_waitcnt lgkmcnt(0)
  s_mov_b32 s24, s6
  s_mov_b32 s25, s7
  s_mov_b32 s26, 50331648
  s_mov_b32 s27, 0x20000
  s_mov_b32 s28, s8
  s_mov_b32 s29, s9
  s_mov_b32 s30, 12582912
  s_mov_b32 s31, 0x20000
  s_cmp_ge_u32 s3, 6
  s_cbranch_scc1 L_sgather
  s_cmp_ge_u32 s3, 3
  s_cselect_b32 s60, 1, 0
  s_mul_i32 s62, s60, 3
  s_sub_u32 s61, s3, s62
  s_mul_i32 s67, s56, 18
  s_add_u32 s67, s67, s60
  s_lshl_b32 s61, s61, 8
  v_and_b32 v240, 15, v0
  v_lshrrev_b32 v241, 4, v0
  v_lshl_add_u32 v242, v240, 4, s61
  v_mul_u32_u24 v243, 768, v241
  v_add_u32 v2, v242, v243
  v_lshl_add_u32 v3, v243, 1, v242
  s_mov_b32 s66, 0
  s_mov_b32 s50, 0x11111111
  s_mov_b32 s51, 0x11111111
  s_and_b32 s62, s2, 7
  s_cmp_ge_u32 s62, 3
  s_cbranch_scc1 L_dl_2
  s_mov_b32 s62, 0
  s_lshl_b32 s63, s62, 1
  s_add_u32 s63, s63, s67
  s_mul_i32 s40, s63, 3072
  s_lshr_b32 s64, s63, 5
  s_mul_i32 s64, s64, 393216
  s_and_b32 s65, s63, 31
  s_mul_i32 s65, s65, 6144
  s_add_u32 s41, s64, s65
  s_cmp_gt_u32 s62, 8
  s_cselect_b32 s40, 0x80000000, s40
  s_cselect_b32 s41, 0x80000000, s41
  s_add_u32 s42, s41, 196608
  buffer_load_dwordx4 v[16:19], v2, s[28:31], s40 offen nt
  buffer_load_dwordx4 v[20:23], v3, s[24:27], s41 offen nt
  buffer_load_dwordx4 v[24:27], v3, s[24:27], s41 offen offset:768 nt
  buffer_load_dwordx4 v[28:31], v3, s[24:27], s42 offen nt
  s_mov_b32 s62, 0
  s_lshl_b32 s63, s62, 1
  s_add_u32 s63, s63, s67
  s_mul_i32 s44, s63, 3072
  s_lshr_b32 s64, s63, 5
  s_mul_i32 s64, s64, 393216
  s_and_b32 s65, s63, 31
  s_mul_i32 s65, s65, 6144
  s_add_u32 s45, s64, s65
  s_cmp_gt_u32 s62, 8
  s_cselect_b32 s44, 0x80000000, s44
  s_cselect_b32 s45, 0x80000000, s45
  s_add_u32 s46, s45, 196608
  s_branch L_dj_3
L_dl_2:
  s_mov_b32 s62, 0
  s_lshl_b32 s63, s62, 1
  s_add_u32 s63, s63, s67
  s_mul_i32 s40, s63, 3072
  s_lshr_b32 s64, s63, 5
  s_mul_i32 s64, s64, 393216
  s_and_b32 s65, s63, 31
  s_mul_i32 s65, s65, 6144
  s_add_u32 s41, s64, s65
  s_cmp_gt_u32 s62, 8
  s_cselect_b32 s40, 0x80000000, s40
  s_cselect_b32 s41, 0x80000000, s41
  s_add_u32 s42, s41, 196608
  buffer_load_dwordx4 v[16:19], v2, s[28:31], s40 offen nt
  buffer_load_dwordx4 v[20:23], v3, s[24:27], s41 offen nt
  buffer_load_dwordx4 v[24:27], v3, s[24:27], s41 offen offset:768 nt
  buffer_load_dwordx4 v[28:31], v3, s[24:27], s42 offen nt
  buffer_load_dwordx4 v[32:35], v3, s[24:27], s42 offen offset:768 nt
  s_mov_b32 s62, 1
  s_lshl_b32 s63, s62, 1
  s_add_u32 s63, s63, s67
  s_mul_i32 s44, s63, 3072
  s_lshr_b32 s64, s63, 5
  s_mul_i32 s64, s64, 393216
  s_and_b32 s65, s63, 31
  s_mul_i32 s65, s65, 6144
  s_add_u32 s45, s64, s65
  s_cmp_gt_u32 s62, 8
  s_cselect_b32 s44, 0x80000000, s44
  s_cselect_b32 s45, 0x80000000, s45
  s_add_u32 s46, s45, 196608
L_dj_3:
  s_mul_i32 s60, s60, 12288
  s_add_u32 s60, s60, s61
  s_mov_b32 s32, s22
  s_mov_b32 s33, s23
  s_mov_b32 s34, 268435456
  s_mov_b32 s35, 0x20000
  v_and_b32 v240, 15, v0
  v_lshrrev_b32 v241, 4, v0
  v_and_b32 v242, 1, v241
  v_lshlrev_b32 v242, 3, v242
  v_xor_b32 v242, v240, v242
  v_mul_u32_u24 v243, 3072, v241
  v_add_u32 v243, s60, v243
  v_xor_b32 v244, 0, v242
  v_lshl_add_u32 v4, v244, 4, v243
  v_xor_b32 v244, 2, v242
  v_lshl_add_u32 v5, v244, 4, v243
  v_xor_b32 v244, 4, v242
  v_lshl_add_u32 v253, v244, 4, v243
  v_xor_b32 v244, 6, v242
  v_lshl_add_u32 v254, v244, 4, v243
  v_bfe_u32 v242, v0, 3, 1
  v_lshlrev_b32 v242, 6, v242
  v_bfe_u32 v243, v0, 2, 1
  v_lshl_add_u32 v243, v241, 2, v243
  v_lshl_add_u32 v242, v243, 2, v242
  s_cmp_ge_u32 s3, 3
  s_cselect_b32 s62, 384, 0
  s_add_u32 s62, s62, 159744
  s_lshr_b32 s63, s61, 1
  s_add_u32 s62, s62, s63
  v_add_u32 v255, s62, v242
  s_barrier
  v_and_b32 v240, 15, v0
  v_lshrrev_b32 v241, 4, v0
  v_and_b32 v242, 7, v240
  v_lshlrev_b32 v242, 1, v242
  v_mul_u32_u24 v243, 768, v240
  v_add_u32 v244, 0, v241
  v_xor_b32 v244, v244, v242
  v_lshl_add_u32 v6, v244, 4, v243
  v_add_u32 v244, 4, v241
  v_xor_b32 v244, v244, v242
  v_lshl_add_u32 v7, v244, 4, v243
  v_add_u32 v244, 8, v241
  v_xor_b32 v244, v244, v242
  v_lshl_add_u32 v8, v244, 4, v243
  v_add_u32 v244, 12, v241
  v_xor_b32 v244, v244, v242
  v_lshl_add_u32 v9, v244, 4, v243
  v_lshrrev_b32 v242, 2, v240
  v_lshl_add_u32 v242, v241, 2, v242
  v_mul_u32_u24 v243, 768, v242
  v_and_b32 v242, 7, v242
  v_lshlrev_b32 v242, 1, v242
  v_and_b32 v244, 3, v240
  v_lshrrev_b32 v245, 1, v244
  v_and_b32 v244, 1, v244
  v_lshl_add_u32 v243, v244, 3, v243
  s_mul_i32 s62, s3, 3
  s_add_u32 s62, s62, 0
  s_lshl_b32 s63, s62, 1
  s_and_b32 s63, s63, 14
  s_lshr_b32 s62, s62, 3
  s_lshl_b32 s62, s62, 8
  v_xor_b32 v244, s63, v242
  v_or_b32 v244, v244, v245
  v_lshl_add_u32 v244, v244, 4, v243
  v_add_u32 v10, s62, v244
  s_mul_i32 s62, s3, 3
  s_add_u32 s62, s62, 1
  s_lshl_b32 s63, s62, 1
  s_and_b32 s63, s63, 14
  s_lshr_b32 s62, s62, 3
  s_lshl_b32 s62, s62, 8
  v_xor_b32 v244, s63, v242
  v_or_b32 v244, v244, v245
  v_lshl_add_u32 v244, v244, 4, v243
  v_add_u32 v11, s62, v244
  s_mul_i32 s62, s3, 3
  s_add_u32 s62, s62, 2
  s_lshl_b32 s63, s62, 1
  s_and_b32 s63, s63, 14
  s_lshr_b32 s62, s62, 3
  s_lshl_b32 s62, s62, 8
  v_xor_b32 v244, s63, v242
  v_or_b32 v244, v244, v245
  v_lshl_add_u32 v244, v244, 4, v243
  v_add_u32 v12, s62, v244
  v_lshlrev_b32 v252, 4, v0
  v_add_u32 v13, 147456, v252
  v_lshlrev_b32 v1, 4, v241
  v_lshlrev_b32 v244, 5, v240
  v_add_u32 v15, 153600, v244
  s_lshl_b32 s62, s3, 2
  v_add_u32 v14, s62, v15
  v_mov_b32 v216, 0x3f803f80
  v_mov_b32 v217, 0x3f803f80
  v_mov_b32 v218, 0x3f803f80
  v_mov_b32 v219, 0x3f803f80
  v_mov_b32 v239, 1.0
  v_mov_b32 v230, 0x3b2aaaab
  v_mov_b32 v232, 0x3727c5ac
  v_mov_b32 v176, 0
  v_mov_b32 v177, 0
  v_mov_b32 v178, 0
  v_mov_b32 v179, 0
  v_mov_b32 v180, 0
  v_mov_b32 v181, 0
  v_mov_b32 v182, 0
  v_mov_b32 v183, 0
  v_mov_b32 v184, 0
  v_mov_b32 v185, 0
  v_mov_b32 v186, 0
  v_mov_b32 v187, 0
  v_mov_b32 v220, 0xff800000
  v_mov_b32 v224, 0
  v_mov_b32 v225, 0
  v_mov_b32 v226, 0
  v_mov_b32 v227, 0
  v_mov_b32 v221, 0
  v_mov_b32 v223, 0
  v_mov_b32 v229, 0
  v_mov_b32 v231, 0
  v_mov_b32 v233, 0
  v_mov_b32 v235, 0
  s_and_b32 s62, s2, 7
  s_cmp_ge_u32 s62, 3
  s_cbranch_scc1 L_dl_4
  s_call_b64 s[68:69], L_fuse0
  s_call_b64 s[68:69], L_fuse1
  s_barrier
  s_call_b64 s[68:69], L_fuse0
  s_call_b64 s[68:69], L_fuse1
  s_barrier
  s_call_b64 s[68:69], L_fuse0
  s_call_b64 s[68:69], L_fuse1
  s_mov_b32 s62, 6
  s_lshl_b32 s63, s62, 1
  s_add_u32 s63, s63, s67
  s_mul_i32 s40, s63, 3072
  s_lshr_b32 s64, s63, 5
  s_mul_i32 s64, s64, 393216
  s_and_b32 s65, s63, 31
  s_mul_i32 s65, s65, 6144
  s_add_u32 s41, s64, s65
  s_cmp_gt_u32 s62, 8
  s_cselect_b32 s40, 0x80000000, s40
  s_cselect_b32 s41, 0x80000000, s41
  s_add_u32 s42, s41, 196608
  buffer_load_dwordx4 v[32:35], v3, s[24:27], s42 offen offset:768 nt
  s_branch L_dj_5
L_dl_4:
  s_call_b64 s[68:69], L_fuseL0
  s_call_b64 s[68:69], L_fuseL1
  s_barrier
  s_call_b64 s[68:69], L_fuseL0
  s_call_b64 s[68:69], L_fuseL1
  s_barrier
  s_call_b64 s[68:69], L_fuseL0
  s_call_b64 s[68:69], L_fuseL1
L_dj_5:
  s_waitcnt lgkmcnt(0)
  s_branch L_sb0
L_sgather:
  v_mov_b32 v2, 0
  v_mov_b32 v3, 0
  v_mov_b32 v255, 0
  v_mov_b32 v4, 0
  v_mov_b32 v5, 0
  v_mov_b32 v253, 0
  v_mov_b32 v254, 0
  v_mov_b32 v20, 0
  v_mov_b32 v24, 163588
  ds_write_b32 v24, v20
  s_waitcnt lgkmcnt(0)
  s_barrier
  s_mov_b32 s67, 0
  s_mov_b32 s66, 0
  s_mov_b32 s50, 0
  s_mov_b32 s51, 0
  s_mov_b32 s40, 0
  s_mov_b32 s44, 0
  s_mov_b32 s41, 0
  s_mov_b32 s45, 0
  s_mov_b32 s42, 0
  s_mov_b32 s46, 0
  s_mov_b32 s32, s22
  s_mov_b32 s33, s23
  s_mov_b32 s34, 268435456
  s_mov_b32 s35, 0x20000
  s_cmp_eq_u32 s3, 7
  s_cbranch_scc1 L_sw7
  buffer_load_dword v17, v2, s[32:35], 0 offen offset:0 sc1
  v_mov_b32 v18, 53248
  v_and_b32 v240, 15, v0
  v_lshrrev_b32 v241, 4, v0
  v_and_b32 v242, 7, v240
  v_lshlrev_b32 v242, 1, v242
  v_mul_u32_u24 v243, 768, v240
  v_add_u32 v244, 0, v241
  v_xor_b32 v244, v244, v242
  v_lshl_add_u32 v6, v244, 4, v243
  v_add_u32 v244, 4, v241
  v_xor_b32 v244, v244, v242
  v_lshl_add_u32 v7, v244, 4, v243
  v_add_u32 v244, 8, v241
  v_xor_b32 v244, v244, v242
  v_lshl_add_u32 v8, v244, 4, v243
  v_add_u32 v244, 12, v241
  v_xor_b32 v244, v244, v242
  v_lshl_add_u32 v9, v244, 4, v243
  v_lshrrev_b32 v242, 2, v240
  v_lshl_add_u32 v242, v241, 2, v242
  v_mul_u32_u24 v243, 768, v242
  v_and_b32 v242, 7, v242
  v_lshlrev_b32 v242, 1, v242
  v_and_b32 v244, 3, v240
  v_lshrrev_b32 v245, 1, v244
  v_and_b32 v244, 1, v244
  v_lshl_add_u32 v243, v244, 3, v243
  s_mul_i32 s62, s3, 3
  s_add_u32 s62, s62, 0
  s_lshl_b32 s63, s62, 1
  s_and_b32 s63, s63, 14
  s_lshr_b32 s62, s62, 3
  s_lshl_b32 s62, s62, 8
  v_xor_b32 v244, s63, v242
  v_or_b32 v244, v244, v245
  v_lshl_add_u32 v244, v244, 4, v243
  v_add_u32 v10, s62, v244
  s_mul_i32 s62, s3, 3
  s_add_u32 s62, s62, 1
  s_lshl_b32 s63, s62, 1
  s_and_b32 s63, s63, 14
  s_lshr_b32 s62, s62, 3
  s_lshl_b32 s62, s62, 8
  v_xor_b32 v244, s63, v242
  v_or_b32 v244, v244, v245
  v_lshl_add_u32 v244, v244, 4, v243
  v_add_u32 v11, s62, v244
  s_mul_i32 s62, s3, 3
  s_add_u32 s62, s62, 2
  s_lshl_b32 s63, s62, 1
  s_and_b32 s63, s63, 14
  s_lshr_b32 s62, s62, 3
  s_lshl_b32 s62, s62, 8
  v_xor_b32 v244, s63, v242
  v_or_b32 v244, v244, v245
  v_lshl_add_u32 v244, v244, 4, v243
  v_add_u32 v12, s62, v244
  v_lshlrev_b32 v252, 4, v0
  v_add_u32 v13, 147456, v252
  v_lshlrev_b32 v1, 4, v241
  v_lshlrev_b32 v244, 5, v240
  v_add_u32 v15, 153600, v244
  s_lshl_b32 s62, s3, 2
  v_add_u32 v14, s62, v15
  v_mov_b32 v216, 0x3f803f80
  v_mov_b32 v217, 0x3f803f80
  v_mov_b32 v218, 0x3f803f80
  v_mov_b32 v219, 0x3f803f80
  v_mov_b32 v239, 1.0
  v_mov_b32 v230, 0x3b2aaaab
  v_mov_b32 v232, 0x3727c5ac
  v_mov_b32 v176, 0
  v_mov_b32 v177, 0
  v_mov_b32 v178, 0
  v_mov_b32 v179, 0
  v_mov_b32 v180, 0
  v_mov_b32 v181, 0
  v_mov_b32 v182, 0
  v_mov_b32 v183, 0
  v_mov_b32 v184, 0
  v_mov_b32 v185, 0
  v_mov_b32 v186, 0
  v_mov_b32 v187, 0
  v_mov_b32 v220, 0xff800000
  v_mov_b32 v224, 0
  v_mov_b32 v225, 0
  v_mov_b32 v226, 0
  v_mov_b32 v227, 0
  v_mov_b32 v221, 0
  v_mov_b32 v223, 0
  v_mov_b32 v229, 0
  v_mov_b32 v231, 0
  v_mov_b32 v233, 0
  v_mov_b32 v235, 0
  s_waitcnt vmcnt(0)
  v_add_u32 v17, 1, v17
  v_mov_b32 v236, 163584
  ds_write_b32 v236, v17
  v_readfirstlane_b32 s70, v17
  s_barrier
  buffer_load_dword v16, v18, s[32:35], 0 offen sc1
  s_barrier
  s_mov_b32 s71, 0
  s_branch L_flgc_7
L_flg_6:
  buffer_load_dword v16, v18, s[32:35], 0 offen sc1
  s_add_u32 s71, s71, 1
  s_cmp_gt_u32 s71, 200000
  s_cbranch_scc1 L_flgd_8
L_flgc_7:
  s_waitcnt vmcnt(0)
  v_cmp_ne_u32 vcc, s70, v16
  s_cbranch_vccnz L_flg_6
L_flgd_8:
  s_waitcnt vmcnt(0)
  s_mov_b32 s62, 20480
  s_add_u32 s63, s62, 4096
  s_add_u32 s64, s62, 8192
  s_mov_b32 s71, 0
L_qk_9:
  buffer_load_dwordx4 v[80:83], v252, s[32:35], s62 offen offset:0 sc1
  buffer_load_dwordx4 v[84:87], v252, s[32:35], s62 offen offset:1024 sc1
  buffer_load_dwordx4 v[88:91], v252, s[32:35], s62 offen offset:2048 sc1
  buffer_load_dwordx4 v[92:95], v252, s[32:35], s62 offen offset:3072 sc1
  buffer_load_dwordx4 v[96:99], v252, s[32:35], s63 offen offset:0 sc1
  buffer_load_dwordx4 v[100:103], v252, s[32:35], s63 offen offset:1024 sc1
  buffer_load_dwordx4 v[104:107], v252, s[32:35], s63 offen offset:2048 sc1
  buffer_load_dwordx4 v[108:111], v252, s[32:35], s63 offen offset:3072 sc1
  buffer_load_dwordx4 v[112:115], v252, s[32:35], s64 offen offset:0 sc1
  buffer_load_dwordx4 v[116:119], v252, s[32:35], s64 offen offset:1024 sc1
  buffer_load_dwordx4 v[120:123], v252, s[32:35], s64 offen offset:2048 sc1
  buffer_load_dwordx4 v[124:127], v252, s[32:35], s64 offen offset:3072 sc1
  s_add_u32 s71, s71, 1
  s_cmp_gt_u32 s71, 200000
  s_cbranch_scc1 L_qkd_10
  s_waitcnt vmcnt(0)
  v_max3_u32 v236, v80, v81, v82
  v_max3_u32 v237, v104, v105, v106
  v_max3_u32 v236, v236, v83, v84
  v_max3_u32 v237, v237, v107, v108
  v_max3_u32 v236, v236, v85, v86
  v_max3_u32 v237, v237, v109, v110
  v_max3_u32 v236, v236, v87, v88
  v_max3_u32 v237, v237, v111, v112
  v_max3_u32 v236, v236, v89, v90
  v_max3_u32 v237, v237, v113, v114
  v_max3_u32 v236, v236, v91, v92
  v_max3_u32 v237, v237, v115, v116
  v_max3_u32 v236, v236, v93, v94
  v_max3_u32 v237, v237, v117, v118
  v_max3_u32 v236, v236, v95, v96
  v_max3_u32 v237, v237, v119, v120
  v_max3_u32 v236, v236, v97, v98
  v_max3_u32 v237, v237, v121, v122
  v_max3_u32 v236, v236, v99, v100
  v_max3_u32 v237, v237, v123, v124
  v_max3_u32 v236, v236, v101, v102
  v_max3_u32 v237, v237, v125, v126
  v_max_u32 v236, v236, v103
  v_max_u32 v237, v237, v127
  v_max_u32 v236, v236, v237
  v_cmp_eq_u32 vcc, -1, v236
  s_cbranch_vccnz L_qk_9
L_qkd_10:
  s_waitcnt vmcnt(0)
  ds_write_b128 v13, v[80:83] offset:0
  ds_write_b128 v13, v[84:87] offset:1024
  ds_write_b128 v13, v[88:91] offset:2048
  ds_write_b128 v13, v[92:95] offset:3072
  ds_write_b128 v13, v[96:99] offset:4096
  ds_write_b128 v13, v[100:103] offset:5120
  ds_write_b128 v13, v[104:107] offset:6144
  ds_write_b128 v13, v[108:111] offset:7168
  ds_write_b128 v13, v[112:115] offset:8192
  ds_write_b128 v13, v[116:119] offset:9216
  ds_write_b128 v13, v[120:123] offset:10240
  ds_write_b128 v13, v[124:127] offset:11264
  v_dot2_f32_bf16 v196, v80, v216, 0
  v_dot2_f32_bf16 v197, v81, v216, 0
  v_dot2_f32_bf16 v198, v82, v216, 0
  v_dot2_f32_bf16 v199, v83, v216, 0
  v_dot2_f32_bf16 v196, v84, v216, v196
  v_dot2_f32_bf16 v197, v85, v216, v197
  v_dot2_f32_bf16 v198, v86, v216, v198
  v_dot2_f32_bf16 v199, v87, v216, v199
  v_dot2_f32_bf16 v196, v88, v216, v196
  v_dot2_f32_bf16 v197, v89, v216, v197
  v_dot2_f32_bf16 v198, v90, v216, v198
  v_dot2_f32_bf16 v199, v91, v216, v199
  v_dot2_f32_bf16 v196, v92, v216, v196
  v_dot2_f32_bf16 v197, v93, v216, v197
  v_dot2_f32_bf16 v198, v94, v216, v198
  v_dot2_f32_bf16 v199, v95, v216, v199
  v_dot2_f32_bf16 v196, v96, v216, v196
  v_dot2_f32_bf16 v197, v97, v216, v197
  v_dot2_f32_bf16 v198, v98, v216, v198
  v_dot2_f32_bf16 v199, v99, v216, v199
  v_dot2_f32_bf16 v196, v100, v216, v196
  v_dot2_f32_bf16 v197, v101, v216, v197
  v_dot2_f32_bf16 v198, v102, v216, v198
  v_dot2_f32_bf16 v199, v103, v216, v199
  v_dot2_f32_bf16 v196, v104, v216, v196
  v_dot2_f32_bf16 v197, v105, v216, v197
  v_dot2_f32_bf16 v198, v106, v216, v198
  v_dot2_f32_bf16 v199, v107, v216, v199
  v_dot2_f32_bf16 v196, v108, v216, v196
  v_dot2_f32_bf16 v197, v109, v216, v197
  v_dot2_f32_bf16 v198, v110, v216, v198
  v_dot2_f32_bf16 v199, v111, v216, v199
  v_dot2_f32_bf16 v196, v112, v216, v196
  v_dot2_f32_bf16 v197, v113, v216, v197
  v_dot2_f32_bf16 v198, v114, v216, v198
  v_dot2_f32_bf16 v199, v115, v216, v199
  v_dot2_f32_bf16 v196, v116, v216, v196
  v_dot2_f32_bf16 v197, v117, v216, v197
  v_dot2_f32_bf16 v198, v118, v216, v198
  v_dot2_f32_bf16 v199, v119, v216, v199
  v_dot2_f32_bf16 v196, v120, v216, v196
  v_dot2_f32_bf16 v197, v121, v216, v197
  v_dot2_f32_bf16 v198, v122, v216, v198
  v_dot2_f32_bf16 v199, v123, v216, v199
  v_dot2_f32_bf16 v196, v124, v216, v196
  v_dot2_f32_bf16 v197, v125, v216, v197
  v_dot2_f32_bf16 v198, v126, v216, v198
  v_dot2_f32_bf16 v199, v127, v216, v199
  s_nop 2
  v_pk_add_f32 v[196:197], v[196:197], v[198:199]
  v_add_f32 v228, v196, v197
  v_mov_b32 v236, v228
  s_nop 1
  v_permlane16_swap_b32 v236, v228
  v_add_f32 v228, v236, v228
  v_mov_b32 v236, v228
  s_nop 1
  v_permlane32_swap_b32 v236, v228
  v_add_f32 v228, v236, v228
  v_and_b32 v236, 15, v0
  v_lshlrev_b32 v236, 2, v236
  v_add_u32 v236, 163600, v236
  ds_write_b32 v236, v228
  s_waitcnt lgkmcnt(0)
  s_branch L_sb0
L_sw7:
  v_and_b32 v240, 15, v0
  v_lshrrev_b32 v241, 4, v0
  v_and_b32 v242, 7, v240
  v_lshlrev_b32 v242, 1, v242
  v_mul_u32_u24 v243, 768, v240
  v_add_u32 v244, 0, v241
  v_xor_b32 v244, v244, v242
  v_lshl_add_u32 v6, v244, 4, v243
  v_add_u32 v244, 4, v241
  v_xor_b32 v244, v244, v242
  v_lshl_add_u32 v7, v244, 4, v243
  v_add_u32 v244, 8, v241
  v_xor_b32 v244, v244, v242
  v_lshl_add_u32 v8, v244, 4, v243
  v_add_u32 v244, 12, v241
  v_xor_b32 v244, v244, v242
  v_lshl_add_u32 v9, v244, 4, v243
  v_lshrrev_b32 v242, 2, v240
  v_lshl_add_u32 v242, v241, 2, v242
  v_mul_u32_u24 v243, 768, v242
  v_and_b32 v242, 7, v242
  v_lshlrev_b32 v242, 1, v242
  v_and_b32 v244, 3, v240
  v_lshrrev_b32 v245, 1, v244
  v_and_b32 v244, 1, v244
  v_lshl_add_u32 v243, v244, 3, v243
  s_mul_i32 s62, s3, 3
  s_add_u32 s62, s62, 0
  s_lshl_b32 s63, s62, 1
  s_and_b32 s63, s63, 14
  s_lshr_b32 s62, s62, 3
  s_lshl_b32 s62, s62, 8
  v_xor_b32 v244, s63, v242
  v_or_b32 v244, v244, v245
  v_lshl_add_u32 v244, v244, 4, v243
  v_add_u32 v10, s62, v244
  s_mul_i32 s62, s3, 3
  s_add_u32 s62, s62, 1
  s_lshl_b32 s63, s62, 1
  s_and_b32 s63, s63, 14
  s_lshr_b32 s62, s62, 3
  s_lshl_b32 s62, s62, 8
  v_xor_b32 v244, s63, v242
  v_or_b32 v244, v244, v245
  v_lshl_add_u32 v244, v244, 4, v243
  v_add_u32 v11, s62, v244
  s_mul_i32 s62, s3, 3
  s_add_u32 s62, s62, 2
  s_lshl_b32 s63, s62, 1
  s_and_b32 s63, s63, 14
  s_lshr_b32 s62, s62, 3
  s_lshl_b32 s62, s62, 8
  v_xor_b32 v244, s63, v242
  v_or_b32 v244, v244, v245
  v_lshl_add_u32 v244, v244, 4, v243
  v_add_u32 v12, s62, v244
  v_lshlrev_b32 v252, 4, v0
  v_add_u32 v13, 147456, v252
  v_lshlrev_b32 v1, 4, v241
  v_lshlrev_b32 v244, 5, v240
  v_add_u32 v15, 153600, v244
  s_lshl_b32 s62, s3, 2
  v_add_u32 v14, s62, v15
  v_mov_b32 v216, 0x3f803f80
  v_mov_b32 v217, 0x3f803f80
  v_mov_b32 v218, 0x3f803f80
  v_mov_b32 v219, 0x3f803f80
  v_mov_b32 v239, 1.0
  v_mov_b32 v230, 0x3b2aaaab
  v_mov_b32 v232, 0x3727c5ac
  v_mov_b32 v176, 0
  v_mov_b32 v177, 0
  v_mov_b32 v178, 0
  v_mov_b32 v179, 0
  v_mov_b32 v180, 0
  v_mov_b32 v181, 0
  v_mov_b32 v182, 0
  v_mov_b32 v183, 0
  v_mov_b32 v184, 0
  v_mov_b32 v185, 0
  v_mov_b32 v186, 0
  v_mov_b32 v187, 0
  v_mov_b32 v220, 0xff800000
  v_mov_b32 v224, 0
  v_mov_b32 v225, 0
  v_mov_b32 v226, 0
  v_mov_b32 v227, 0
  v_mov_b32 v221, 0
  v_mov_b32 v223, 0
  v_mov_b32 v229, 0
  v_mov_b32 v231, 0
  v_mov_b32 v233, 0
  v_mov_b32 v235, 0
  s_waitcnt vmcnt(0)
  s_barrier
  s_barrier
L_sb0:
  s_barrier
  v_and_b32 v238, 15, v0
  v_lshlrev_b32 v238, 2, v238
  v_add_u32 v238, 163600, v238
  v_mov_b32 v236, 163584
  ds_read_b32 v237, v236
  ds_read_b32 v228, v238
  ds_read_b128 v[80:83], v13 offset:0
  ds_read_b128 v[84:87], v13 offset:1024
  ds_read_b128 v[88:91], v13 offset:2048
  ds_read_b128 v[92:95], v13 offset:3072
  ds_read_b128 v[96:99], v13 offset:4096
  ds_read_b128 v[100:103], v13 offset:5120
  ds_read_b128 v[104:107], v13 offset:6144
  ds_read_b128 v[108:111], v13 offset:7168
  ds_read_b128 v[112:115], v13 offset:8192
  ds_read_b128 v[116:119], v13 offset:9216
  ds_read_b128 v[120:123], v13 offset:10240
  ds_read_b128 v[124:127], v13 offset:11264
  s_mul_i32 s77, s56, 9
  v_mov_b32 v76, 0
  v_mov_b32 v77, 0
  v_mov_b32 v78, 0
  v_mov_b32 v79, 0
  s_waitcnt lgkmcnt(0)
  v_readfirstlane_b32 s70, v237
  s_barrier
  s_cmp_ge_u32 s3, 6
  s_cbranch_scc1 L_noext_12
  v_add_u32 v236, 0xffffec00, v255
  s_mov_b64 exec, s[50:51]
  ds_write_b32 v236, v140
  ds_write_b32 v236, v141 offset:8
  s_mov_b64 exec, -1
  s_mov_b32 s62, 7
  s_lshl_b32 s63, s62, 1
  s_add_u32 s63, s63, s67
  s_mul_i32 s40, s63, 3072
  s_lshr_b32 s64, s63, 5
  s_mul_i32 s64, s64, 393216
  s_and_b32 s65, s63, 31
  s_mul_i32 s65, s65, 6144
  s_add_u32 s41, s64, s65
  s_cmp_gt_u32 s62, 8
  s_cselect_b32 s40, 0x80000000, s40
  s_cselect_b32 s41, 0x80000000, s41
  s_add_u32 s42, s41, 196608
  buffer_load_dwordx4 v[36:39], v2, s[28:31], s40 offen nt
  buffer_load_dwordx4 v[40:43], v3, s[24:27], s41 offen nt
  buffer_load_dwordx4 v[44:47], v3, s[24:27], s41 offen offset:768 nt
  buffer_load_dwordx4 v[48:51], v3, s[24:27], s42 offen nt
  buffer_load_dwordx4 v[52:55], v3, s[24:27], s42 offen offset:768 nt
L_noext_12:
  s_mov_b32 s47, 0xc2700000
  v_mov_b32 v220, 0
  s_mul_i32 s73, s3, 12288
  s_mul_i32 s62, s3, 384
  s_add_u32 s49, s62, 159744
  s_lshr_b32 s62, s3, 1
  s_add_u32 s52, s62, s77
  s_lshl_b32 s62, s62, 10
  s_and_b32 s63, s3, 1
  s_lshl_b32 s63, s63, 3
  s_add_u32 s53, s62, s63
  s_call_b64 s[68:69], L_sp
  s_waitcnt lgkmcnt(0)
  s_barrier
  v_mov_b32 v236, 163588
  ds_read_b32 v237, v236
  ds_read_b128 v[128:131], v13 offset:0
  ds_read_b64_tr_b16 v[132:133], v10 offset:0
  ds_read_b64_tr_b16 v[134:135], v10 offset:12288
  ds_read_b64_tr_b16 v[136:137], v11 offset:0
  ds_read_b64_tr_b16 v[138:139], v11 offset:12288
  ds_read_b64_tr_b16 v[140:141], v12 offset:0
  ds_read_b64_tr_b16 v[142:143], v12 offset:12288
  s_waitcnt lgkmcnt(7)
  v_readfirstlane_b32 s62, v237
  s_cmp_lg_u32 s62, 0
  s_cbranch_scc1 L_slow1
  ds_read_b128 v[144:147], v13 offset:1024
  ds_read_b64_tr_b16 v[148:149], v10 offset:24576
  ds_read_b64_tr_b16 v[150:151], v10 offset:36864
  ds_read_b64_tr_b16 v[152:153], v11 offset:24576
  ds_read_b64_tr_b16 v[154:155], v11 offset:36864
  ds_read_b64_tr_b16 v[156:157], v12 offset:24576
  ds_read_b64_tr_b16 v[158:159], v12 offset:36864
  v_pk_add_f32 v[224:225], v[224:225], v[76:77]
  v_pk_add_f32 v[226:227], v[226:227], v[78:79]
  s_waitcnt lgkmcnt(11)
  v_mfma_f32_16x16x32_bf16 v[176:179], v[132:135], v[128:131], v[176:179]
  s_waitcnt lgkmcnt(9)
  v_mfma_f32_16x16x32_bf16 v[180:183], v[136:139], v[128:131], v[180:183]
  s_waitcnt lgkmcnt(7)
  v_mfma_f32_16x16x32_bf16 v[184:187], v[140:143], v[128:131], v[184:187]
  ds_read_b128 v[128:131], v13 offset:2048
  ds_read_b64_tr_b16 v[132:133], v10 offset:49152
  ds_read_b64_tr_b16 v[134:135], v10 offset:61440
  ds_read_b64_tr_b16 v[136:137], v11 offset:49152
  ds_read_b64_tr_b16 v[138:139], v11 offset:61440
  ds_read_b64_tr_b16 v[140:141], v12 offset:49152
  ds_read_b64_tr_b16 v[142:143], v12 offset:61440
  v_mov_b32 v76, 0
  v_mov_b32 v77, 0
  v_mov_b32 v78, 0
  v_mov_b32 v79, 0
  s_waitcnt lgkmcnt(11)
  v_mfma_f32_16x16x32_bf16 v[176:179], v[148:151], v[144:147], v[176:179]
  s_waitcnt lgkmcnt(9)
  v_mfma_f32_16x16x32_bf16 v[180:183], v[152:155], v[144:147], v[180:183]
  s_waitcnt lgkmcnt(7)
  v_mfma_f32_16x16x32_bf16 v[184:187], v[156:159], v[144:147], v[184:187]
  s_mov_b32 s81, 73728
  ds_read_b128 v[144:147], v13 offset:3072
  v_add_u32 v248, s81, v10
  ds_read_b64_tr_b16 v[148:149], v248 offset:0
  ds_read_b64_tr_b16 v[150:151], v248 offset:12288
  v_add_u32 v249, s81, v11
  ds_read_b64_tr_b16 v[152:153], v249 offset:0
  ds_read_b64_tr_b16 v[154:155], v249 offset:12288
  v_add_u32 v250, s81, v12
  ds_read_b64_tr_b16 v[156:157], v250 offset:0
  ds_read_b64_tr_b16 v[158:159], v250 offset:12288
  s_waitcnt lgkmcnt(11)
  v_mfma_f32_16x16x32_bf16 v[176:179], v[132:135], v[128:131], v[176:179]
  s_waitcnt lgkmcnt(9)
  v_mfma_f32_16x16x32_bf16 v[180:183], v[136:139], v[128:131], v[180:183]
  s_waitcnt lgkmcnt(7)
  v_mfma_f32_16x16x32_bf16 v[184:187], v[140:143], v[128:131], v[184:187]
  s_waitcnt lgkmcnt(4)
  v_mfma_f32_16x16x32_bf16 v[176:179], v[148:151], v[144:147], v[176:179]
  s_waitcnt lgkmcnt(2)
  v_mfma_f32_16x16x32_bf16 v[180:183], v[152:155], v[144:147], v[180:183]
  s_waitcnt lgkmcnt(0)
  v_mfma_f32_16x16x32_bf16 v[184:187], v[156:159], v[144:147], v[184:187]
L_safter1:
  s_mov_b32 s47, 0xff61b1e6
  s_barrier
  s_cmp_ge_u32 s3, 6
  s_cbranch_scc1 L_s67
  s_mov_b32 s62, 8
  s_lshl_b32 s63, s62, 1
  s_add_u32 s63, s63, s67
  s_mul_i32 s44, s63, 3072
  s_lshr_b32 s64, s63, 5
  s_mul_i32 s64, s64, 393216
  s_and_b32 s65, s63, 31
  s_mul_i32 s65, s65, 6144
  s_add_u32 s45, s64, s65
  s_cmp_gt_u32 s62, 8
  s_cselect_b32 s44, 0x80000000, s44
  s_cselect_b32 s45, 0x80000000, s45
  s_add_u32 s46, s45, 196608
  buffer_load_dwordx4 v[56:59], v2, s[28:31], s44 offen nt
  buffer_load_dwordx4 v[60:63], v3, s[24:27], s45 offen nt
  buffer_load_dwordx4 v[64:67], v3, s[24:27], s45 offen offset:768 nt
  buffer_load_dwordx4 v[68:71], v3, s[24:27], s46 offen nt
  buffer_load_dwordx4 v[72:75], v3, s[24:27], s46 offen offset:768 nt
  s_call_b64 s[68:69], L_fuseR0
  s_call_b64 s[68:69], L_fuseR1
  s_call_b64 s[68:69], L_fuseR2
  s_branch L_sx
L_s67:
  s_and_b32 s63, s3, 1
  s_add_u32 s62, s63, 8
  s_mul_i32 s73, s62, 12288
  s_mul_i32 s62, s63, 384
  s_add_u32 s49, s62, 162816
  s_add_u32 s52, s77, 4
  s_lshl_b32 s63, s63, 3
  s_add_u32 s53, s63, 0
  s_call_b64 s[68:69], L_sp
  s_and_b32 s63, s3, 1
  s_add_u32 s62, s63, 10
  s_mul_i32 s73, s62, 12288
  s_mul_i32 s62, s63, 384
  s_add_u32 s49, s62, 154624
  s_add_u32 s52, s77, 5
  s_lshl_b32 s63, s63, 3
  s_add_u32 s53, s63, 1024
  s_call_b64 s[68:69], L_sp
L_sx:
  v_and_b32 v236, 7, v0
  v_lshlrev_b32 v236, 3, v236
  v_add_u32 v236, s3, v236
  s_mov_b32 s62, 29184
  v_mul_lo_u32 v236, v236, s62
  v_bfe_u32 v237, v0, 3, 1
  v_lshl_add_u32 v236, v237, 6, v236
  v_lshrrev_b32 v237, 4, v0
  v_lshl_add_u32 v196, v237, 4, v236
  s_mov_b32 s62, 2654435761
  v_mul_lo_u32 v237, v237, s62
  v_add_u32 v197, s70, v237
  v_and_b32 v236, 15, v0
  v_lshlrev_b32 v236, 6, v236
  v_bfe_u32 v237, v0, 4, 1
  v_lshl_add_u32 v236, v237, 2, v236
  s_lshl_b32 s62, s3, 3
  s_add_u32 s62, s62, 152576
  v_add_u32 v198, s62, v236
  v_and_b32 v236, 15, v0
  v_lshlrev_b32 v236, 6, v236
  v_add_u32 v199, 152576, v236
  s_waitcnt lgkmcnt(0)
  s_barrier
  s_cmp_ge_u32 s3, 6
  s_cbranch_scc1 L_nosp_13
  s_mul_i32 s73, s3, 12288
  s_mul_i32 s62, s3, 384
  s_add_u32 s49, s62, 159744
  s_lshr_b32 s62, s3, 1
  s_add_u32 s52, s62, s77
  s_add_u32 s52, s52, 6
  s_lshl_b32 s62, s62, 10
  s_and_b32 s63, s3, 1
  s_lshl_b32 s63, s63, 3
  s_add_u32 s62, s62, s63
  s_add_u32 s53, s62, 2048
  s_call_b64 s[68:69], L_sp
L_nosp_13:
  v_pk_add_f32 v[240:241], v[224:225], v[76:77]
  v_pk_add_f32 v[242:243], v[226:227], v[78:79]
  v_add_f32 v246, v240, v241
  v_add_f32 v247, v242, v243
  s_nop 1
  v_permlane16_swap_b32 v246, v247
  v_add_f32 v246, v246, v247
  v_mov_b32 v247, v246
  s_nop 1
  v_permlane32_swap_b32 v247, v246
  v_add_f32 v246, v246, v247
  ds_write_b32 v198, v246
  s_waitcnt lgkmcnt(0)
  s_barrier
  v_mov_b32 v236, 163588
  ds_read_b32 v237, v236
  s_mov_b32 s81, 98304
  ds_read_b128 v[128:131], v13 offset:0
  v_add_u32 v248, s81, v10
  ds_read_b64_tr_b16 v[132:133], v248 offset:0
  ds_read_b64_tr_b16 v[134:135], v248 offset:12288
  v_add_u32 v249, s81, v11
  ds_read_b64_tr_b16 v[136:137], v249 offset:0
  ds_read_b64_tr_b16 v[138:139], v249 offset:12288
  v_add_u32 v250, s81, v12
  ds_read_b64_tr_b16 v[140:141], v250 offset:0
  ds_read_b64_tr_b16 v[142:143], v250 offset:12288
  s_waitcnt lgkmcnt(7)
  v_readfirstlane_b32 s62, v237
  s_cmp_lg_u32 s62, 0
  s_cbranch_scc1 L_slow
  s_mov_b32 s81, 122880
  ds_read_b128 v[144:147], v13 offset:1024
  v_add_u32 v248, s81, v10
  ds_read_b64_tr_b16 v[148:149], v248 offset:0
  ds_read_b64_tr_b16 v[150:151], v248 offset:12288
  v_add_u32 v249, s81, v11
  ds_read_b64_tr_b16 v[152:153], v249 offset:0
  ds_read_b64_tr_b16 v[154:155], v249 offset:12288
  v_add_u32 v250, s81, v12
  ds_read_b64_tr_b16 v[156:157], v250 offset:0
  ds_read_b64_tr_b16 v[158:159], v250 offset:12288
  s_waitcnt lgkmcnt(11)
  v_mfma_f32_16x16x32_bf16 v[176:179], v[132:135], v[128:131], v[176:179]
  s_waitcnt lgkmcnt(9)
  v_mfma_f32_16x16x32_bf16 v[180:183], v[136:139], v[128:131], v[180:183]
  s_waitcnt lgkmcnt(7)
  v_mfma_f32_16x16x32_bf16 v[184:187], v[140:143], v[128:131], v[184:187]
  ds_read_b128 v[128:131], v13 offset:2048
  ds_read_b64_tr_b16 v[132:133], v10 offset:0
  ds_read_b64_tr_b16 v[134:135], v10 offset:12288
  ds_read_b64_tr_b16 v[136:137], v11 offset:0
  ds_read_b64_tr_b16 v[138:139], v11 offset:12288
  ds_read_b64_tr_b16 v[140:141], v12 offset:0
  ds_read_b64_tr_b16 v[142:143], v12 offset:12288
  s_waitcnt lgkmcnt(11)
  v_mfma_f32_16x16x32_bf16 v[176:179], v[148:151], v[144:147], v[176:179]
  s_waitcnt lgkmcnt(9)
  v_mfma_f32_16x16x32_bf16 v[180:183], v[152:155], v[144:147], v[180:183]
  s_waitcnt lgkmcnt(7)
  v_mfma_f32_16x16x32_bf16 v[184:187], v[156:159], v[144:147], v[184:187]
  ds_read_b128 v[144:147], v13 offset:3072
  ds_read_b64_tr_b16 v[148:149], v10 offset:24576
  ds_read_b64_tr_b16 v[150:151], v10 offset:36864
  ds_read_b64_tr_b16 v[152:153], v11 offset:24576
  ds_read_b64_tr_b16 v[154:155], v11 offset:36864
  ds_read_b64_tr_b16 v[156:157], v12 offset:24576
  ds_read_b64_tr_b16 v[158:159], v12 offset:36864
  s_waitcnt lgkmcnt(11)
  v_mfma_f32_16x16x32_bf16 v[176:179], v[132:135], v[128:131], v[176:179]
  s_waitcnt lgkmcnt(9)
  v_mfma_f32_16x16x32_bf16 v[180:183], v[136:139], v[128:131], v[180:183]
  s_waitcnt lgkmcnt(7)
  v_mfma_f32_16x16x32_bf16 v[184:187], v[140:143], v[128:131], v[184:187]
  ds_read_b128 v[128:131], v13 offset:4096
  ds_read_b64_tr_b16 v[132:133], v10 offset:49152
  ds_read_b64_tr_b16 v[134:135], v10 offset:61440
  ds_read_b64_tr_b16 v[136:137], v11 offset:49152
  ds_read_b64_tr_b16 v[138:139], v11 offset:61440
  ds_read_b64_tr_b16 v[140:141], v12 offset:49152
  ds_read_b64_tr_b16 v[142:143], v12 offset:61440
  s_waitcnt lgkmcnt(11)
  v_mfma_f32_16x16x32_bf16 v[176:179], v[148:151], v[144:147], v[176:179]
  s_waitcnt lgkmcnt(9)
  v_mfma_f32_16x16x32_bf16 v[180:183], v[152:155], v[144:147], v[180:183]
  s_waitcnt lgkmcnt(7)
  v_mfma_f32_16x16x32_bf16 v[184:187], v[156:159], v[144:147], v[184:187]
  ds_read_b128 v[16:19], v199 offset:0
  ds_read_b128 v[20:23], v199 offset:16
  ds_read_b128 v[24:27], v199 offset:32
  ds_read_b128 v[28:31], v199 offset:48
  s_waitcnt lgkmcnt(8)
  v_mfma_f32_16x16x32_bf16 v[176:179], v[132:135], v[128:131], v[176:179]
  s_waitcnt lgkmcnt(6)
  v_mfma_f32_16x16x32_bf16 v[180:183], v[136:139], v[128:131], v[180:183]
  s_waitcnt lgkmcnt(4)
  v_mfma_f32_16x16x32_bf16 v[184:187], v[140:143], v[128:131], v[184:187]
  s_waitcnt lgkmcnt(0)
  v_pk_add_f32 v[16:17], v[16:17], v[18:19]
  v_pk_add_f32 v[20:21], v[20:21], v[22:23]
  v_pk_add_f32 v[24:25], v[24:25], v[26:27]
  v_pk_add_f32 v[28:29], v[28:29], v[30:31]
  v_pk_add_f32 v[16:17], v[16:17], v[20:21]
  v_pk_add_f32 v[24:25], v[24:25], v[28:29]
  v_pk_add_f32 v[16:17], v[16:17], v[24:25]
  v_rcp_f32 v18, v16
  v_log_f32 v21, v16
  v_mul_f32 v20, v17, v18
  v_add_f32 v22, v220, v21
L_spub:
  s_lshl_b32 s62, s56, 7
  s_add_u32 s62, s62, 131072
  s_add_u32 s63, s62, 1867776
  v_mov_b32 v155, s70
  v_xor_b32 v159, v22, v197
  v_pk_fma_f32 v[176:177], v[176:177], v[18:19], v[20:21] op_sel_hi:[1,0,0] neg_lo:[0,0,1] neg_hi:[0,0,1]
  v_pk_fma_f32 v[178:179], v[178:179], v[18:19], v[20:21] op_sel_hi:[1,0,0] neg_lo:[0,0,1] neg_hi:[0,0,1]
  v_pk_fma_f32 v[180:181], v[180:181], v[18:19], v[20:21] op_sel_hi:[1,0,0] neg_lo:[0,0,1] neg_hi:[0,0,1]
  v_pk_fma_f32 v[182:183], v[182:183], v[18:19], v[20:21] op_sel_hi:[1,0,0] neg_lo:[0,0,1] neg_hi:[0,0,1]
  v_pk_fma_f32 v[184:185], v[184:185], v[18:19], v[20:21] op_sel_hi:[1,0,0] neg_lo:[0,0,1] neg_hi:[0,0,1]
  v_pk_fma_f32 v[186:187], v[186:187], v[18:19], v[20:21] op_sel_hi:[1,0,0] neg_lo:[0,0,1] neg_hi:[0,0,1]
  v_cvt_pk_f16_f32 v152, v176, v177
  v_cvt_pk_f16_f32 v153, v178, v179
  v_cvt_pk_f16_f32 v154, v180, v181
  v_cvt_pk_f16_f32 v156, v182, v183
  v_cvt_pk_f16_f32 v157, v184, v185
  v_cvt_pk_f16_f32 v158, v186, v187
  v_mov_b32 v160, v156
  v_mov_b32 v161, v157
  v_mov_b32 v162, v158
  v_mov_b32 v163, v159
  v_mov_b32_dpp v156, v152 row_ror:8 row_mask:0xf bank_mask:0x3
  v_mov_b32_dpp v157, v153 row_ror:8 row_mask:0xf bank_mask:0x3
  v_mov_b32_dpp v158, v154 row_ror:8 row_mask:0xf bank_mask:0x3
  v_mov_b32_dpp v159, v155 quad_perm:[0,1,2,3] row_mask:0xf bank_mask:0x3
  v_mov_b32_dpp v152, v160 row_ror:8 row_mask:0xf bank_mask:0xc
  v_mov_b32_dpp v153, v161 row_ror:8 row_mask:0xf bank_mask:0xc
  v_mov_b32_dpp v154, v162 row_ror:8 row_mask:0xf bank_mask:0xc
  v_mov_b32_dpp v155, v163 row_ror:8 row_mask:0xf bank_mask:0xc
  buffer_store_dwordx4 v[152:155], v196, s[32:35], s62 offen sc1
  buffer_store_dwordx4 v[156:159], v196, s[32:35], s63 offen sc1
  s_mov_b32 s79, s56
  s_cmp_ge_u32 s79, 128
  s_cbranch_scc1 L_sdone
  v_lshrrev_b32 v84, 3, v0
  s_lshl_b32 s62, s3, 5
  v_add_u32 v86, s62, v84
  v_and_b32 v85, 7, v0
  v_lshlrev_b32 v85, 4, v85
  s_mov_b32 s62, 228
  v_add_u32 v84, 0, v86
  v_cmp_gt_u32 s[40:41], s62, v84
  s_nop 1
  v_cndmask_b32 v84, 0, v84, s[40:41]
  v_lshl_add_u32 v80, v84, 7, v85
  v_add_u32 v84, 8, v86
  v_cmp_gt_u32 s[42:43], s62, v84
  s_nop 1
  v_cndmask_b32 v84, 0, v84, s[42:43]
  v_lshl_add_u32 v81, v84, 7, v85
  v_add_u32 v84, 16, v86
  v_cmp_gt_u32 s[44:45], s62, v84
  s_nop 1
  v_cndmask_b32 v84, 0, v84, s[44:45]
  v_lshl_add_u32 v82, v84, 7, v85
  v_add_u32 v84, 24, v86
  v_cmp_gt_u32 s[46:47], s62, v84
  s_nop 1
  v_cndmask_b32 v84, 0, v84, s[46:47]
  v_lshl_add_u32 v83, v84, 7, v85
  s_sleep 34
  s_mul_i32 s62, s79, 29184
  s_add_u32 s62, s62, 131072
  buffer_load_dwordx4 v[16:19], v80, s[32:35], s62 offen sc1
  buffer_load_dwordx4 v[20:23], v81, s[32:35], s62 offen sc1
  buffer_load_dwordx4 v[24:27], v82, s[32:35], s62 offen sc1
  buffer_load_dwordx4 v[28:31], v83, s[32:35], s62 offen sc1
  s_mov_b32 s63, s62
  v_and_b32 v84, 3, v0
  v_bfe_u32 v85, v0, 2, 1
  v_mul_u32_u24 v84, v84, v85
  s_mov_b32 s62, 2654435761
  v_mul_lo_u32 v84, v84, s62
  v_add_u32 v90, s70, v84
  v_lshrrev_b32 v84, 4, v0
  v_and_b32 v85, 1, v84
  v_lshlrev_b32 v85, 1, v85
  v_lshrrev_b32 v88, 1, v84
  v_add_u32 v85, v85, v88
  v_bfe_u32 v88, v0, 2, 1
  v_mul_u32_u24 v88, 3, v88
  v_add_u32 v85, v85, v88
  v_lshrrev_b32 v88, 1, v85
  v_lshlrev_b32 v88, 4, v88
  v_and_b32 v85, 1, v85
  v_lshl_add_u32 v88, v85, 1, v88
  v_and_b32 v85, 3, v0
  v_lshl_add_u32 v88, v85, 2, v88
  s_and_b32 s62, s79, 7
  s_mul_i32 s62, s62, 48
  v_add_u32 v88, s62, v88
  v_lshlrev_b32 v87, 1, v88
  v_lshrrev_b32 v85, 4, v0
  v_lshlrev_b32 v85, 3, v85
  v_and_b32 v88, 7, v0
  v_add_u32 v85, v85, v88
  v_lshlrev_b32 v89, 3, v85
  s_lshl_b32 s62, s3, 8
  s_add_u32 s62, s62, 155648
  v_add_u32 v88, s62, v89
  v_add_u32 v89, 155648, v89
  s_mov_b32 s62, s63
  v_mov_b32 v33, 0
  v_mov_b32 v35, 0
  v_mov_b32 v37, 0
  v_mov_b32 v39, 0
  s_mov_b32 s71, 0
  s_branch L_redc_15
L_red_14:
  s_mov_b64 exec, s[48:49]
  s_cbranch_execz L_skipld_17
  buffer_load_dwordx4 v[16:19], v80, s[32:35], s62 offen sc1
L_skipld_17:
  s_mov_b64 exec, s[50:51]
  s_cbranch_execz L_skipld_18
  buffer_load_dwordx4 v[20:23], v81, s[32:35], s62 offen sc1
L_skipld_18:
  s_mov_b64 exec, s[52:53]
  s_cbranch_execz L_skipld_19
  buffer_load_dwordx4 v[24:27], v82, s[32:35], s62 offen sc1
L_skipld_19:
  s_mov_b64 exec, s[54:55]
  s_cbranch_execz L_skipld_20
  buffer_load_dwordx4 v[28:31], v83, s[32:35], s62 offen sc1
L_skipld_20:
  s_mov_b64 exec, -1
  s_add_u32 s71, s71, 1
  s_cmp_gt_u32 s71, 200000
  s_cbranch_scc1 L_redd_16
L_redc_15:
  s_waitcnt vmcnt(0)
  v_xor_b32 v32, v90, v19
  v_xor_b32 v34, v90, v23
  v_xor_b32 v36, v90, v27
  v_xor_b32 v38, v90, v31
  v_mov_b32_dpp v33, v32 quad_perm:[0,0,0,0] row_mask:0xf bank_mask:0xa
  v_mov_b32_dpp v35, v34 quad_perm:[0,0,0,0] row_mask:0xf bank_mask:0xa
  v_mov_b32_dpp v37, v36 quad_perm:[0,0,0,0] row_mask:0xf bank_mask:0xa
  v_mov_b32_dpp v39, v38 quad_perm:[0,0,0,0] row_mask:0xf bank_mask:0xa
  v_cmp_ne_u32 s[48:49], v32, v33
  v_cmp_ne_u32 s[50:51], v34, v35
  v_cmp_ne_u32 s[52:53], v36, v37
  v_cmp_ne_u32 s[54:55], v38, v39
  s_or_b64 s[60:61], s[48:49], s[50:51]
  s_or_b64 vcc, s[52:53], s[54:55]
  s_or_b64 s[60:61], s[60:61], vcc
  s_cbranch_scc0 L_redd_16
  v_xor_b32 v40, v32, v33
  v_xor_b32 v41, v34, v35
  v_xor_b32 v42, v36, v37
  v_xor_b32 v43, v38, v39
  v_or_b32_dpp v40, v40, v40 row_half_mirror row_mask:0xf bank_mask:0xf
  v_or_b32_dpp v41, v41, v41 row_half_mirror row_mask:0xf bank_mask:0xf
  v_or_b32_dpp v42, v42, v42 row_half_mirror row_mask:0xf bank_mask:0xf
  v_or_b32_dpp v43, v43, v43 row_half_mirror row_mask:0xf bank_mask:0xf
  v_or_b32_dpp v40, v40, v40 quad_perm:[1,0,3,2] row_mask:0xf bank_mask:0xf
  v_or_b32_dpp v41, v41, v41 quad_perm:[1,0,3,2] row_mask:0xf bank_mask:0xf
  v_or_b32_dpp v42, v42, v42 quad_perm:[1,0,3,2] row_mask:0xf bank_mask:0xf
  v_or_b32_dpp v43, v43, v43 quad_perm:[1,0,3,2] row_mask:0xf bank_mask:0xf
  v_or_b32_dpp v40, v40, v40 quad_perm:[2,3,0,1] row_mask:0xf bank_mask:0xf
  v_or_b32_dpp v41, v41, v41 quad_perm:[2,3,0,1] row_mask:0xf bank_mask:0xf
  v_or_b32_dpp v42, v42, v42 quad_perm:[2,3,0,1] row_mask:0xf bank_mask:0xf
  v_or_b32_dpp v43, v43, v43 quad_perm:[2,3,0,1] row_mask:0xf bank_mask:0xf
  v_cmp_ne_u32 s[48:49], 0, v40
  v_cmp_ne_u32 s[50:51], 0, v41
  v_cmp_ne_u32 s[52:53], 0, v42
  v_cmp_ne_u32 s[54:55], 0, v43
  s_branch L_red_14
L_redd_16:
  s_waitcnt vmcnt(0)
  v_mov_b32_dpp v32, v32 row_shl:4 row_mask:0xf bank_mask:0x5
  v_mov_b32_dpp v34, v34 row_shl:4 row_mask:0xf bank_mask:0x5
  v_mov_b32_dpp v36, v36 row_shl:4 row_mask:0xf bank_mask:0x5
  v_mov_b32_dpp v38, v38 row_shl:4 row_mask:0xf bank_mask:0x5
  v_mov_b32 v85, 0xff800000
  v_cndmask_b32 v32, v85, v32, s[40:41]
  v_cndmask_b32 v34, v85, v34, s[42:43]
  v_cndmask_b32 v36, v85, v36, s[44:45]
  v_cndmask_b32 v38, v85, v38, s[46:47]
  v_max3_f32 v84, v32, v34, v36
  v_max_f32 v84, v84, v38
  s_nop 1
  v_max_f32_dpp v84, v84, v84 row_ror:8 row_mask:0xf bank_mask:0xf
  v_mov_b32 v85, v84
  s_nop 1
  v_permlane16_swap_b32 v85, v84
  v_max_f32 v84, v85, v84
  v_mov_b32 v85, v84
  s_nop 1
  v_permlane32_swap_b32 v85, v84
  v_max_f32 v84, v85, v84
  v_sub_f32 v40, v32, v84
  v_sub_f32 v41, v34, v84
  v_sub_f32 v42, v36, v84
  v_sub_f32 v43, v38, v84
  v_exp_f32 v40, v40
  v_exp_f32 v41, v41
  v_exp_f32 v42, v42
  v_exp_f32 v43, v43
  s_lshl_b32 s62, s3, 2
  s_add_u32 s62, s62, 154112
  v_mov_b32 v85, s62
  ds_write_b32 v85, v84
  v_fma_mix_f32 v44, v16, v40, 0 op_sel_hi:[1,0,0]
  v_fma_mix_f32 v45, v16, v40, 0 op_sel:[1,0,0] op_sel_hi:[1,0,0]
  v_fma_mix_f32 v46, v17, v40, 0 op_sel_hi:[1,0,0]
  v_fma_mix_f32 v47, v17, v40, 0 op_sel:[1,0,0] op_sel_hi:[1,0,0]
  v_fma_mix_f32 v48, v18, v40, 0 op_sel_hi:[1,0,0]
  v_fma_mix_f32 v49, v18, v40, 0 op_sel:[1,0,0] op_sel_hi:[1,0,0]
  v_fma_mix_f32 v44, v20, v41, v44 op_sel_hi:[1,0,0]
  v_fma_mix_f32 v45, v20, v41, v45 op_sel:[1,0,0] op_sel_hi:[1,0,0]
  v_fma_mix_f32 v46, v21, v41, v46 op_sel_hi:[1,0,0]
  v_fma_mix_f32 v47, v21, v41, v47 op_sel:[1,0,0] op_sel_hi:[1,0,0]
  v_fma_mix_f32 v48, v22, v41, v48 op_sel_hi:[1,0,0]
  v_fma_mix_f32 v49, v22, v41, v49 op_sel:[1,0,0] op_sel_hi:[1,0,0]
  v_fma_mix_f32 v44, v24, v42, v44 op_sel_hi:[1,0,0]
  v_fma_mix_f32 v45, v24, v42, v45 op_sel:[1,0,0] op_sel_hi:[1,0,0]
  v_fma_mix_f32 v46, v25, v42, v46 op_sel_hi:[1,0,0]
  v_fma_mix_f32 v47, v25, v42, v47 op_sel:[1,0,0] op_sel_hi:[1,0,0]
  v_fma_mix_f32 v48, v26, v42, v48 op_sel_hi:[1,0,0]
  v_fma_mix_f32 v49, v26, v42, v49 op_sel:[1,0,0] op_sel_hi:[1,0,0]
  v_fma_mix_f32 v44, v28, v43, v44 op_sel_hi:[1,0,0]
  v_fma_mix_f32 v45, v28, v43, v45 op_sel:[1,0,0] op_sel_hi:[1,0,0]
  v_fma_mix_f32 v46, v29, v43, v46 op_sel_hi:[1,0,0]
  v_fma_mix_f32 v47, v29, v43, v47 op_sel:[1,0,0] op_sel_hi:[1,0,0]
  v_fma_mix_f32 v48, v30, v43, v48 op_sel_hi:[1,0,0]
  v_fma_mix_f32 v49, v30, v43, v49 op_sel:[1,0,0] op_sel_hi:[1,0,0]
  v_pk_add_f32 v[40:41], v[40:41], v[42:43]
  v_add_f32 v50, v40, v41
  v_mov_b32 v51, 0
  v_permlane32_swap_b32 v44, v46
  v_permlane32_swap_b32 v45, v47
  v_permlane32_swap_b32 v48, v50
  v_permlane32_swap_b32 v49, v51
  v_add_f32 v44, v44, v46
  v_add_f32 v45, v45, v47
  v_add_f32 v48, v48, v50
  v_add_f32 v49, v49, v51
  s_nop 0
  v_permlane16_swap_b32 v44, v48
  v_permlane16_swap_b32 v45, v49
  v_add_f32 v44, v44, v48
  v_add_f32 v45, v45, v49
  s_nop 0
  v_add_f32_dpp v44, v44, v44 row_ror:8 row_mask:0xf bank_mask:0xf
  v_add_f32_dpp v45, v45, v45 row_ror:8 row_mask:0xf bank_mask:0xf
  ds_write_b64 v88, v[44:45]
  s_waitcnt lgkmcnt(0)
  s_barrier
  s_cmp_lg_u32 s3, 0
  s_cbranch_scc1 L_sdone
  v_mov_b32 v85, 154112
  ds_read_b128 v[40:43], v85
  ds_read_b128 v[44:47], v85 offset:16
  ds_read_b64 v[16:17], v89 offset:0
  ds_read_b64 v[18:19], v89 offset:256
  ds_read_b64 v[20:21], v89 offset:512
  ds_read_b64 v[22:23], v89 offset:768
  ds_read_b64 v[24:25], v89 offset:1024
  ds_read_b64 v[26:27], v89 offset:1280
  ds_read_b64 v[28:29], v89 offset:1536
  ds_read_b64 v[30:31], v89 offset:1792
  s_lshr_b32 s63, s79, 3
  s_mul_i32 s63, s63, 768
  s_add_u32 s63, s63, 36864
  v_and_b32 v88, 8, v0
  v_cmp_eq_u32 vcc, 0, v88
  v_cmp_gt_u32 s[64:65], 48, v0
  s_and_b64 s[64:65], vcc, s[64:65]
  s_waitcnt lgkmcnt(8)
  v_max3_f32 v84, v40, v41, v42
  v_max3_f32 v85, v43, v44, v45
  v_max3_f32 v84, v84, v46, v47
  v_max_f32 v84, v84, v85
  v_pk_add_f32 v[40:41], v[40:41], v[84:85] op_sel_hi:[1,0] neg_lo:[0,1] neg_hi:[0,1]
  v_pk_add_f32 v[42:43], v[42:43], v[84:85] op_sel_hi:[1,0] neg_lo:[0,1] neg_hi:[0,1]
  v_pk_add_f32 v[44:45], v[44:45], v[84:85] op_sel_hi:[1,0] neg_lo:[0,1] neg_hi:[0,1]
  v_pk_add_f32 v[46:47], v[46:47], v[84:85] op_sel_hi:[1,0] neg_lo:[0,1] neg_hi:[0,1]
  v_exp_f32 v40, v40
  v_exp_f32 v41, v41
  v_exp_f32 v42, v42
  v_exp_f32 v43, v43
  v_exp_f32 v44, v44
  v_exp_f32 v45, v45
  v_exp_f32 v46, v46
  v_exp_f32 v47, v47
  s_waitcnt lgkmcnt(0)
  v_pk_mul_f32 v[32:33], v[16:17], v[40:41] op_sel_hi:[1,0]
  v_pk_fma_f32 v[32:33], v[18:19], v[40:41], v[32:33] op_sel:[0,1,0] op_sel_hi:[1,1,1]
  v_pk_fma_f32 v[32:33], v[20:21], v[42:43], v[32:33] op_sel_hi:[1,0,1]
  v_pk_fma_f32 v[32:33], v[22:23], v[42:43], v[32:33] op_sel:[0,1,0] op_sel_hi:[1,1,1]
  v_pk_fma_f32 v[32:33], v[24:25], v[44:45], v[32:33] op_sel_hi:[1,0,1]
  v_pk_fma_f32 v[32:33], v[26:27], v[44:45], v[32:33] op_sel:[0,1,0] op_sel_hi:[1,1,1]
  v_pk_fma_f32 v[32:33], v[28:29], v[46:47], v[32:33] op_sel_hi:[1,0,1]
  v_pk_fma_f32 v[32:33], v[30:31], v[46:47], v[32:33] op_sel:[0,1,0] op_sel_hi:[1,1,1]
  s_nop 0
  v_readlane_b32 s62, v32, 48
  s_nop 1
  v_rcp_f32 v84, s62
  s_nop 0
  v_pk_mul_f32 v[32:33], v[32:33], v[84:85] op_sel_hi:[1,0]
  v_cvt_pk_bf16_f32 v32, v32, v33
  v_min_u32 v32, -2, v32
  s_mov_b64 exec, s[64:65]
  buffer_store_dword v32, v87, s[32:35], s63 offen sc1
  s_mov_b64 exec, -1
L_sdone:
  s_endpgm
L_slow1:
  s_waitcnt lgkmcnt(0)
  v_mov_b32 v220, 0xff800000
  v_mov_b32 v76, 0
  v_mov_b32 v77, 0
  v_mov_b32 v78, 0
  v_mov_b32 v79, 0
  s_mov_b32 s76, 8
  s_mov_b32 s79, 0
  s_mov_b32 s78, 0
  s_add_u32 s74, s77, 0
  s_mov_b32 s59, 0
  s_call_b64 s[68:69], L_batch
  s_branch L_safter1
L_slow:
  s_waitcnt lgkmcnt(0)
  s_mov_b32 s76, 4
  s_mov_b32 s79, 4
  s_mov_b32 s78, 8
  s_add_u32 s74, s77, 4
  s_mov_b32 s59, 0
  s_call_b64 s[68:69], L_batch
  s_mov_b32 s76, 6
  s_mov_b32 s79, 0
  s_mov_b32 s78, 0
  s_add_u32 s74, s77, 6
  s_mov_b32 s59, 1
  s_call_b64 s[68:69], L_batch
  ds_read_b128 v[16:19], v199 offset:0
  ds_read_b128 v[20:23], v199 offset:16
  ds_read_b128 v[24:27], v199 offset:32
  ds_read_b128 v[28:31], v199 offset:48
  s_waitcnt lgkmcnt(0)
  v_pk_add_f32 v[16:17], v[16:17], v[18:19]
  v_pk_add_f32 v[20:21], v[20:21], v[22:23]
  v_pk_add_f32 v[24:25], v[24:25], v[26:27]
  v_pk_add_f32 v[28:29], v[28:29], v[30:31]
  v_pk_add_f32 v[16:17], v[16:17], v[20:21]
  v_pk_add_f32 v[24:25], v[24:25], v[28:29]
  v_pk_add_f32 v[16:17], v[16:17], v[24:25]
  v_rcp_f32 v18, v16
  v_log_f32 v21, v16
  v_mul_f32 v20, v17, v18
  v_add_f32 v22, v220, v21
  s_branch L_spub
L_sp:
  s_call_b64 s[54:55], L_sphase
  v_pk_add_f32 v[240:241], v[212:213], v[220:221] op_sel_hi:[1,0] neg_lo:[0,1] neg_hi:[0,1]
  v_pk_add_f32 v[242:243], v[214:215], v[220:221] op_sel_hi:[1,0] neg_lo:[0,1] neg_hi:[0,1]
  v_max3_f32 v236, v240, v241, v242
  v_max_f32 v236, v236, v243
  v_exp_f32 v240, v240
  v_exp_f32 v241, v241
  v_exp_f32 v242, v242
  v_exp_f32 v243, v243
  v_cmp_lt_f32 vcc, 0x42200000, v236
  v_cmp_gt_f32 s[60:61], s47, v236
  s_or_b64 vcc, vcc, s[60:61]
  v_pk_add_f32 v[76:77], v[76:77], v[240:241]
  v_pk_add_f32 v[76:77], v[76:77], v[242:243]
  v_pk_mul_f32 v[240:241], v[240:241], v[208:209]
  v_pk_mul_f32 v[242:243], v[242:243], v[210:211]
  v_cvt_pk_bf16_f32 v244, v240, v241
  v_cvt_pk_bf16_f32 v245, v242, v243
  ds_write_b64 v238, v[244:245]
  v_pk_fma_f32 v[78:79], v[240:241], v[204:205], v[78:79]
  v_pk_fma_f32 v[78:79], v[242:243], v[206:207], v[78:79]
  s_cbranch_vccz L_sp_ret
  v_mov_b32 v236, 163588
  v_mov_b32 v237, 1
  ds_write_b32 v236, v237
L_sp_ret:
  s_setpc_b64 s[68:69]
L_sphase:
  v_add_u32 v248, s73, v6
  v_add_u32 v249, s73, v7
  v_add_u32 v250, s73, v8
  v_add_u32 v251, s73, v9
  v_add_u32 v237, s49, v1
  ds_read_b128 v[192:195], v237 offset:0
  ds_read_b128 v[200:203], v237 offset:64
  ds_read_b128 v[212:215], v237 offset:128
  ds_read_b128 v[208:211], v237 offset:192
  ds_read_b128 v[204:207], v237 offset:256
  ds_read_b128 v[240:243], v237 offset:320
  ds_read_b128 v[128:131], v248 offset:0
  ds_read_b128 v[132:135], v249 offset:0
  ds_read_b128 v[136:139], v250 offset:0
  ds_read_b128 v[140:143], v251 offset:0
  ds_read_b128 v[144:147], v248 offset:256
  ds_read_b128 v[148:151], v249 offset:256
  ds_read_b128 v[152:155], v250 offset:256
  ds_read_b128 v[156:159], v251 offset:256
  ds_read_b128 v[160:163], v248 offset:512
  s_cmp_lt_u32 s52, 2048
  s_cselect_b32 s75, 0, 0xf149f2ca
  v_mov_b32 v234, s75
  v_add_u32 v238, s53, v13
  s_waitcnt lgkmcnt(9)
  ds_read_b128 v[164:167], v249 offset:512
  ds_read_b128 v[168:171], v250 offset:512
  ds_read_b128 v[172:175], v251 offset:512
  s_waitcnt lgkmcnt(11)
  v_mfma_f32_16x16x32_bf16 v[188:191], v[128:131], v[80:83], 0
  v_pk_add_f32 v[192:193], v[192:193], v[212:213]
  v_pk_add_f32 v[194:195], v[194:195], v[214:215]
  s_waitcnt lgkmcnt(10)
  v_mfma_f32_16x16x32_bf16 v[188:191], v[132:135], v[84:87], v[188:191]
  v_pk_add_f32 v[200:201], v[200:201], v[208:209]
  v_pk_add_f32 v[202:203], v[202:203], v[210:211]
  s_waitcnt lgkmcnt(9)
  v_mfma_f32_16x16x32_bf16 v[188:191], v[136:139], v[88:91], v[188:191]
  v_pk_add_f32 v[192:193], v[192:193], v[204:205]
  v_pk_add_f32 v[194:195], v[194:195], v[206:207]
  s_waitcnt lgkmcnt(8)
  v_mfma_f32_16x16x32_bf16 v[188:191], v[140:143], v[92:95], v[188:191]
  v_pk_add_f32 v[200:201], v[200:201], v[240:241]
  v_pk_add_f32 v[202:203], v[202:203], v[242:243]
  s_waitcnt lgkmcnt(7)
  v_mfma_f32_16x16x32_bf16 v[188:191], v[144:147], v[96:99], v[188:191]
  v_pk_mul_f32 v[204:205], v[192:193], v[230:231] op_sel_hi:[1,0]
  v_pk_mul_f32 v[206:207], v[194:195], v[230:231] op_sel_hi:[1,0]
  s_waitcnt lgkmcnt(6)
  v_mfma_f32_16x16x32_bf16 v[188:191], v[148:151], v[100:103], v[188:191]
  v_pk_fma_f32 v[208:209], v[200:201], v[230:231], v[232:233] op_sel_hi:[1,0,0]
  v_pk_fma_f32 v[210:211], v[202:203], v[230:231], v[232:233] op_sel_hi:[1,0,0]
  s_waitcnt lgkmcnt(5)
  v_mfma_f32_16x16x32_bf16 v[188:191], v[152:155], v[104:107], v[188:191]
  v_pk_fma_f32 v[208:209], v[204:205], v[204:205], v[208:209] neg_lo:[1,0,0] neg_hi:[1,0,0]
  v_pk_fma_f32 v[210:211], v[206:207], v[206:207], v[210:211] neg_lo:[1,0,0] neg_hi:[1,0,0]
  s_waitcnt lgkmcnt(4)
  v_mfma_f32_16x16x32_bf16 v[188:191], v[156:159], v[108:111], v[188:191]
  v_max_f32 v208, v232, v208
  v_max_f32 v209, v232, v209
  s_waitcnt lgkmcnt(3)
  v_mfma_f32_16x16x32_bf16 v[188:191], v[160:163], v[112:115], v[188:191]
  v_max_f32 v210, v232, v210
  v_max_f32 v211, v232, v211
  s_waitcnt lgkmcnt(2)
  v_mfma_f32_16x16x32_bf16 v[188:191], v[164:167], v[116:119], v[188:191]
  v_rsq_f32 v208, v208
  v_rsq_f32 v209, v209
  s_waitcnt lgkmcnt(1)
  v_mfma_f32_16x16x32_bf16 v[188:191], v[168:171], v[120:123], v[188:191]
  v_rsq_f32 v210, v210
  v_rsq_f32 v211, v211
  s_waitcnt lgkmcnt(0)
  v_mfma_f32_16x16x32_bf16 v[188:191], v[172:175], v[124:127], v[188:191]
  v_pk_mul_f32 v[192:193], v[204:205], v[228:229] op_sel_hi:[1,0]
  v_pk_mul_f32 v[194:195], v[206:207], v[228:229] op_sel_hi:[1,0]
  s_nop 5
  v_pk_add_f32 v[212:213], v[188:189], v[192:193] neg_lo:[0,1] neg_hi:[0,1]
  v_pk_add_f32 v[214:215], v[190:191], v[194:195] neg_lo:[0,1] neg_hi:[0,1]
  v_pk_fma_f32 v[212:213], v[212:213], v[208:209], v[234:235] op_sel_hi:[1,1,0]
  v_pk_fma_f32 v[214:215], v[214:215], v[210:211], v[234:235] op_sel_hi:[1,1,0]
  s_setpc_b64 s[54:55]
L_batch:
  s_sub_u32 s72, s3, s79
  s_cmp_ge_u32 s72, s76
  s_cbranch_scc1 L_b_bar2
  s_add_u32 s63, s72, s78
  s_mul_i32 s73, s63, 12288
  s_mul_i32 s62, s63, 384
  s_add_u32 s49, s62, 159744
  s_add_u32 s62, s62, 150784
  s_cmp_ge_u32 s63, 10
  s_cselect_b32 s49, s62, s49
  s_lshr_b32 s62, s72, 1
  s_add_u32 s52, s62, s74
  s_lshl_b32 s62, s62, 10
  s_and_b32 s63, s72, 1
  s_lshl_b32 s63, s63, 3
  s_add_u32 s53, s62, s63
  s_call_b64 s[54:55], L_sphase
  v_max3_f32 v236, v212, v213, v214
  v_max_f32 v236, v236, v215
  v_mov_b32 v237, v236
  s_nop 1
  v_permlane16_swap_b32 v237, v236
  v_max_f32 v236, v237, v236
  v_mov_b32 v237, v236
  s_nop 1
  v_permlane32_swap_b32 v237, v236
  v_max_f32 v236, v237, v236
  ds_write_b32 v14, v236
L_b_bar2:
  s_waitcnt lgkmcnt(0)
  s_barrier
  ds_read_b128 v[240:243], v15
  ds_read_b128 v[244:247], v15 offset:16
  v_mov_b32 v236, 163588
  v_mov_b32 v237, 0
  ds_write_b32 v236, v237
  s_waitcnt lgkmcnt(1)
  v_max3_f32 v236, v240, v241, v242
  v_max3_f32 v237, v243, v244, v245
  v_max3_f32 v236, v236, v246, v247
  v_max3_f32 v236, v236, v237, v220
  v_sub_f32 v222, v220, v236
  v_mov_b32 v220, v236
  v_exp_f32 v222, v222
  s_cmp_ge_u32 s72, s76
  s_cbranch_scc1 L_b_nop
  v_pk_add_f32 v[240:241], v[212:213], v[220:221] op_sel_hi:[1,0] neg_lo:[0,1] neg_hi:[0,1]
  v_pk_add_f32 v[242:243], v[214:215], v[220:221] op_sel_hi:[1,0] neg_lo:[0,1] neg_hi:[0,1]
  v_exp_f32 v240, v240
  v_exp_f32 v241, v241
  v_exp_f32 v242, v242
  v_exp_f32 v243, v243
  v_pk_mul_f32 v[224:225], v[224:225], v[222:223] op_sel_hi:[1,0]
  v_pk_mul_f32 v[226:227], v[226:227], v[222:223] op_sel_hi:[1,0]
  v_pk_add_f32 v[224:225], v[224:225], v[240:241]
  v_pk_add_f32 v[224:225], v[224:225], v[242:243]
  v_pk_mul_f32 v[240:241], v[240:241], v[208:209]
  v_pk_mul_f32 v[242:243], v[242:243], v[210:211]
  v_cvt_pk_bf16_f32 v244, v240, v241
  v_cvt_pk_bf16_f32 v245, v242, v243
  ds_write_b64 v238, v[244:245]
  v_pk_fma_f32 v[226:227], v[240:241], v[204:205], v[226:227]
  v_pk_fma_f32 v[226:227], v[242:243], v[206:207], v[226:227]
  s_branch L_b_acc
L_b_nop:
  v_pk_mul_f32 v[224:225], v[224:225], v[222:223] op_sel_hi:[1,0]
  v_pk_mul_f32 v[226:227], v[226:227], v[222:223] op_sel_hi:[1,0]
L_b_acc:
  v_pk_mul_f32 v[176:177], v[176:177], v[222:223] op_sel_hi:[1,0]
  v_pk_mul_f32 v[178:179], v[178:179], v[222:223] op_sel_hi:[1,0]
  v_pk_mul_f32 v[180:181], v[180:181], v[222:223] op_sel_hi:[1,0]
  v_pk_mul_f32 v[182:183], v[182:183], v[222:223] op_sel_hi:[1,0]
  v_pk_mul_f32 v[184:185], v[184:185], v[222:223] op_sel_hi:[1,0]
  v_pk_mul_f32 v[186:187], v[186:187], v[222:223] op_sel_hi:[1,0]
  s_cmp_eq_u32 s59, 0
  s_cbranch_scc1 L_b_bar3
  v_add_f32 v246, v224, v225
  v_add_f32 v247, v226, v227
  s_nop 1
  v_permlane16_swap_b32 v246, v247
  v_add_f32 v246, v246, v247
  v_mov_b32 v247, v246
  s_nop 1
  v_permlane32_swap_b32 v247, v246
  v_add_f32 v246, v246, v247
  ds_write_b32 v198, v246
L_b_bar3:
  s_waitcnt lgkmcnt(0)
  s_barrier
  s_lshr_b32 s80, s76, 1
  s_mul_i32 s81, s78, 12288
  ds_read_b128 v[128:131], v13 offset:0
  v_add_u32 v248, s81, v10
  ds_read_b64_tr_b16 v[132:133], v248 offset:0
  ds_read_b64_tr_b16 v[134:135], v248 offset:12288
  v_add_u32 v249, s81, v11
  ds_read_b64_tr_b16 v[136:137], v249 offset:0
  ds_read_b64_tr_b16 v[138:139], v249 offset:12288
  v_add_u32 v250, s81, v12
  ds_read_b64_tr_b16 v[140:141], v250 offset:0
  ds_read_b64_tr_b16 v[142:143], v250 offset:12288
  s_cmp_le_u32 s80, 1
  s_cbranch_scc1 L_pvl0
  s_add_u32 s81, s81, 24576
  ds_read_b128 v[144:147], v13 offset:1024
  v_add_u32 v248, s81, v10
  ds_read_b64_tr_b16 v[148:149], v248 offset:0
  ds_read_b64_tr_b16 v[150:151], v248 offset:12288
  v_add_u32 v249, s81, v11
  ds_read_b64_tr_b16 v[152:153], v249 offset:0
  ds_read_b64_tr_b16 v[154:155], v249 offset:12288
  v_add_u32 v250, s81, v12
  ds_read_b64_tr_b16 v[156:157], v250 offset:0
  ds_read_b64_tr_b16 v[158:159], v250 offset:12288
  s_waitcnt lgkmcnt(11)
  v_mfma_f32_16x16x32_bf16 v[176:179], v[132:135], v[128:131], v[176:179]
  s_waitcnt lgkmcnt(9)
  v_mfma_f32_16x16x32_bf16 v[180:183], v[136:139], v[128:131], v[180:183]
  s_waitcnt lgkmcnt(7)
  v_mfma_f32_16x16x32_bf16 v[184:187], v[140:143], v[128:131], v[184:187]
  s_cmp_le_u32 s80, 2
  s_cbranch_scc1 L_pvl1
  s_add_u32 s81, s81, 24576
  ds_read_b128 v[128:131], v13 offset:2048
  v_add_u32 v248, s81, v10
  ds_read_b64_tr_b16 v[132:133], v248 offset:0
  ds_read_b64_tr_b16 v[134:135], v248 offset:12288
  v_add_u32 v249, s81, v11
  ds_read_b64_tr_b16 v[136:137], v249 offset:0
  ds_read_b64_tr_b16 v[138:139], v249 offset:12288
  v_add_u32 v250, s81, v12
  ds_read_b64_tr_b16 v[140:141], v250 offset:0
  ds_read_b64_tr_b16 v[142:143], v250 offset:12288
  s_waitcnt lgkmcnt(11)
  v_mfma_f32_16x16x32_bf16 v[176:179], v[148:151], v[144:147], v[176:179]
  s_waitcnt lgkmcnt(9)
  v_mfma_f32_16x16x32_bf16 v[180:183], v[152:155], v[144:147], v[180:183]
  s_waitcnt lgkmcnt(7)
  v_mfma_f32_16x16x32_bf16 v[184:187], v[156:159], v[144:147], v[184:187]
  s_cmp_le_u32 s80, 3
  s_cbranch_scc1 L_pvl0
  s_add_u32 s81, s81, 24576
  ds_read_b128 v[144:147], v13 offset:3072
  v_add_u32 v248, s81, v10
  ds_read_b64_tr_b16 v[148:149], v248 offset:0
  ds_read_b64_tr_b16 v[150:151], v248 offset:12288
  v_add_u32 v249, s81, v11
  ds_read_b64_tr_b16 v[152:153], v249 offset:0
  ds_read_b64_tr_b16 v[154:155], v249 offset:12288
  v_add_u32 v250, s81, v12
  ds_read_b64_tr_b16 v[156:157], v250 offset:0
  ds_read_b64_tr_b16 v[158:159], v250 offset:12288
  s_waitcnt lgkmcnt(11)
  v_mfma_f32_16x16x32_bf16 v[176:179], v[132:135], v[128:131], v[176:179]
  s_waitcnt lgkmcnt(9)
  v_mfma_f32_16x16x32_bf16 v[180:183], v[136:139], v[128:131], v[180:183]
  s_waitcnt lgkmcnt(7)
  v_mfma_f32_16x16x32_bf16 v[184:187], v[140:143], v[128:131], v[184:187]
L_pvl1:
  s_waitcnt lgkmcnt(4)
  v_mfma_f32_16x16x32_bf16 v[176:179], v[148:151], v[144:147], v[176:179]
  s_waitcnt lgkmcnt(2)
  v_mfma_f32_16x16x32_bf16 v[180:183], v[152:155], v[144:147], v[180:183]
  s_waitcnt lgkmcnt(0)
  v_mfma_f32_16x16x32_bf16 v[184:187], v[156:159], v[144:147], v[184:187]
  s_setpc_b64 s[68:69]
L_pvl0:
  s_waitcnt lgkmcnt(4)
  v_mfma_f32_16x16x32_bf16 v[176:179], v[132:135], v[128:131], v[176:179]
  s_waitcnt lgkmcnt(2)
  v_mfma_f32_16x16x32_bf16 v[180:183], v[136:139], v[128:131], v[180:183]
  s_waitcnt lgkmcnt(0)
  v_mfma_f32_16x16x32_bf16 v[184:187], v[140:143], v[128:131], v[184:187]
  s_setpc_b64 s[68:69]
L_fuseR1:
  s_waitcnt vmcnt(9)
  v_lshlrev_b32 v144, 16, v36
  v_and_b32 v145, 0xffff0000, v36
  v_lshlrev_b32 v146, 16, v37
  v_and_b32 v147, 0xffff0000, v37
  v_lshlrev_b32 v148, 16, v38
  v_and_b32 v149, 0xffff0000, v38
  v_lshlrev_b32 v150, 16, v39
  v_and_b32 v151, 0xffff0000, v39
  s_waitcnt vmcnt(8)
  v_dot2_f32_bf16 v152, v40, s57, v144
  v_dot2_f32_bf16 v153, v40, s58, v145
  v_dot2_f32_bf16 v154, v41, s57, v146
  v_dot2_f32_bf16 v155, v41, s58, v147
  v_dot2_f32_bf16 v156, v42, s57, v148
  v_dot2_f32_bf16 v157, v42, s58, v149
  v_dot2_f32_bf16 v158, v43, s57, v150
  v_dot2_f32_bf16 v159, v43, s58, v151
  v_cvt_pk_bf16_f32 v160, v152, v153
  v_cvt_pk_bf16_f32 v161, v154, v155
  v_cvt_pk_bf16_f32 v162, v156, v157
  v_cvt_pk_bf16_f32 v163, v158, v159
  ds_write_b128 v4, v[160:163] offset:0
  v_dot2_f32_bf16 v128, v160, v216, 0
  v_dot2_f32_bf16 v132, v160, v160, 0
  v_dot2_f32_bf16 v128, v161, v216, v128
  v_dot2_f32_bf16 v132, v161, v161, v132
  v_dot2_f32_bf16 v128, v162, v216, v128
  v_dot2_f32_bf16 v132, v162, v162, v132
  v_dot2_f32_bf16 v128, v163, v216, v128
  v_dot2_f32_bf16 v132, v163, v163, v132
  s_waitcnt vmcnt(7)
  v_dot2_f32_bf16 v152, v44, s57, v144
  v_dot2_f32_bf16 v153, v44, s58, v145
  v_dot2_f32_bf16 v154, v45, s57, v146
  v_dot2_f32_bf16 v155, v45, s58, v147
  v_dot2_f32_bf16 v156, v46, s57, v148
  v_dot2_f32_bf16 v157, v46, s58, v149
  v_dot2_f32_bf16 v158, v47, s57, v150
  v_dot2_f32_bf16 v159, v47, s58, v151
  v_cvt_pk_bf16_f32 v164, v152, v153
  v_cvt_pk_bf16_f32 v165, v154, v155
  v_cvt_pk_bf16_f32 v166, v156, v157
  v_cvt_pk_bf16_f32 v167, v158, v159
  ds_write_b128 v5, v[164:167] offset:768
  v_add_f32_dpp v136, v128, v128 row_ror:8 row_mask:0xf bank_mask:0x3
  v_dot2_f32_bf16 v129, v164, v216, 0
  v_dot2_f32_bf16 v133, v164, v164, 0
  v_dot2_f32_bf16 v129, v165, v216, v129
  v_dot2_f32_bf16 v133, v165, v165, v133
  v_dot2_f32_bf16 v129, v166, v216, v129
  v_dot2_f32_bf16 v133, v166, v166, v133
  v_dot2_f32_bf16 v129, v167, v216, v129
  v_dot2_f32_bf16 v133, v167, v167, v133
  v_add_f32_dpp v136, v132, v132 row_ror:8 row_mask:0xf bank_mask:0xc
  s_waitcnt vmcnt(6)
  v_dot2_f32_bf16 v152, v48, s57, v144
  v_dot2_f32_bf16 v153, v48, s58, v145
  v_dot2_f32_bf16 v154, v49, s57, v146
  v_dot2_f32_bf16 v155, v49, s58, v147
  v_dot2_f32_bf16 v156, v50, s57, v148
  v_dot2_f32_bf16 v157, v50, s58, v149
  v_dot2_f32_bf16 v158, v51, s57, v150
  v_dot2_f32_bf16 v159, v51, s58, v151
  v_cvt_pk_bf16_f32 v160, v152, v153
  v_cvt_pk_bf16_f32 v161, v154, v155
  v_cvt_pk_bf16_f32 v162, v156, v157
  v_cvt_pk_bf16_f32 v163, v158, v159
  ds_write_b128 v253, v[160:163] offset:1536
  v_add_f32_dpp v137, v129, v129 row_ror:8 row_mask:0xf bank_mask:0x3
  v_dot2_f32_bf16 v130, v160, v216, 0
  v_dot2_f32_bf16 v134, v160, v160, 0
  v_dot2_f32_bf16 v130, v161, v216, v130
  v_dot2_f32_bf16 v134, v161, v161, v134
  v_dot2_f32_bf16 v130, v162, v216, v130
  v_dot2_f32_bf16 v134, v162, v162, v134
  v_dot2_f32_bf16 v130, v163, v216, v130
  v_dot2_f32_bf16 v134, v163, v163, v134
  v_add_f32_dpp v137, v133, v133 row_ror:8 row_mask:0xf bank_mask:0xc
  s_waitcnt vmcnt(5)
  v_dot2_f32_bf16 v152, v52, s57, v144
  v_dot2_f32_bf16 v153, v52, s58, v145
  v_dot2_f32_bf16 v154, v53, s57, v146
  v_dot2_f32_bf16 v155, v53, s58, v147
  v_dot2_f32_bf16 v156, v54, s57, v148
  v_dot2_f32_bf16 v157, v54, s58, v149
  v_dot2_f32_bf16 v158, v55, s57, v150
  v_dot2_f32_bf16 v159, v55, s58, v151
  v_cvt_pk_bf16_f32 v164, v152, v153
  v_cvt_pk_bf16_f32 v165, v154, v155
  v_cvt_pk_bf16_f32 v166, v156, v157
  v_cvt_pk_bf16_f32 v167, v158, v159
  ds_write_b128 v254, v[164:167] offset:2304
  v_add_f32_dpp v138, v130, v130 row_ror:8 row_mask:0xf bank_mask:0x3
  v_dot2_f32_bf16 v131, v164, v216, 0
  v_dot2_f32_bf16 v135, v164, v164, 0
  v_dot2_f32_bf16 v131, v165, v216, v131
  v_dot2_f32_bf16 v135, v165, v165, v135
  v_dot2_f32_bf16 v131, v166, v216, v131
  v_dot2_f32_bf16 v135, v166, v166, v135
  v_dot2_f32_bf16 v131, v167, v216, v131
  v_dot2_f32_bf16 v135, v167, v167, v135
  v_add_f32_dpp v138, v134, v134 row_ror:8 row_mask:0xf bank_mask:0xc
  s_mov_b32 s62, 24576
  s_cmp_eq_u32 s66, 5
  s_cselect_b32 s62, 0xfffe2000, s62
  v_add_f32_dpp v140, v136, v136 row_half_mirror row_mask:0xf bank_mask:0x5
  v_add_f32_dpp v139, v131, v131 row_ror:8 row_mask:0xf bank_mask:0x3
  v_add_u32 v4, s62, v4
  v_add_f32_dpp v140, v137, v137 row_half_mirror row_mask:0xf bank_mask:0xa
  v_add_f32_dpp v139, v135, v135 row_ror:8 row_mask:0xf bank_mask:0xc
  v_add_f32_dpp v141, v138, v138 row_half_mirror row_mask:0xf bank_mask:0x5
  v_add_u32 v5, s62, v5
  v_add_f32_dpp v140, v140, v140 quad_perm:[1,0,3,2] row_mask:0xf bank_mask:0xf
  v_add_f32_dpp v141, v139, v139 row_half_mirror row_mask:0xf bank_mask:0xa
  v_add_u32 v253, s62, v253
  v_add_f32_dpp v140, v140, v140 quad_perm:[2,3,0,1] row_mask:0xf bank_mask:0xf
  v_add_f32_dpp v141, v141, v141 quad_perm:[1,0,3,2] row_mask:0xf bank_mask:0xf
  v_add_u32 v254, s62, v254
  s_mov_b32 s62, 768
  v_add_f32_dpp v141, v141, v141 quad_perm:[2,3,0,1] row_mask:0xf bank_mask:0xf
  s_mov_b64 exec, s[50:51]
  ds_write_b32 v255, v140
  ds_write_b32 v255, v141 offset:8
  s_mov_b64 exec, -1
  s_add_u32 s66, s66, 1
  v_add_u32 v255, s62, v255
  s_setpc_b64 s[68:69]
L_fuseR2:
  s_waitcnt vmcnt(4)
  v_lshlrev_b32 v144, 16, v56
  v_and_b32 v145, 0xffff0000, v56
  v_lshlrev_b32 v146, 16, v57
  v_and_b32 v147, 0xffff0000, v57
  v_lshlrev_b32 v148, 16, v58
  v_and_b32 v149, 0xffff0000, v58
  v_lshlrev_b32 v150, 16, v59
  v_and_b32 v151, 0xffff0000, v59
  s_waitcnt vmcnt(3)
  v_dot2_f32_bf16 v152, v60, s57, v144
  v_dot2_f32_bf16 v153, v60, s58, v145
  v_dot2_f32_bf16 v154, v61, s57, v146
  v_dot2_f32_bf16 v155, v61, s58, v147
  v_dot2_f32_bf16 v156, v62, s57, v148
  v_dot2_f32_bf16 v157, v62, s58, v149
  v_dot2_f32_bf16 v158, v63, s57, v150
  v_dot2_f32_bf16 v159, v63, s58, v151
  v_cvt_pk_bf16_f32 v160, v152, v153
  v_cvt_pk_bf16_f32 v161, v154, v155
  v_cvt_pk_bf16_f32 v162, v156, v157
  v_cvt_pk_bf16_f32 v163, v158, v159
  ds_write_b128 v4, v[160:163] offset:0
  v_dot2_f32_bf16 v128, v160, v216, 0
  v_dot2_f32_bf16 v132, v160, v160, 0
  v_dot2_f32_bf16 v128, v161, v216, v128
  v_dot2_f32_bf16 v132, v161, v161, v132
  v_dot2_f32_bf16 v128, v162, v216, v128
  v_dot2_f32_bf16 v132, v162, v162, v132
  v_dot2_f32_bf16 v128, v163, v216, v128
  v_dot2_f32_bf16 v132, v163, v163, v132
  s_waitcnt vmcnt(2)
  v_dot2_f32_bf16 v152, v64, s57, v144
  v_dot2_f32_bf16 v153, v64, s58, v145
  v_dot2_f32_bf16 v154, v65, s57, v146
  v_dot2_f32_bf16 v155, v65, s58, v147
  v_dot2_f32_bf16 v156, v66, s57, v148
  v_dot2_f32_bf16 v157, v66, s58, v149
  v_dot2_f32_bf16 v158, v67, s57, v150
  v_dot2_f32_bf16 v159, v67, s58, v151
  v_cvt_pk_bf16_f32 v164, v152, v153
  v_cvt_pk_bf16_f32 v165, v154, v155
  v_cvt_pk_bf16_f32 v166, v156, v157
  v_cvt_pk_bf16_f32 v167, v158, v159
  ds_write_b128 v5, v[164:167] offset:768
  v_add_f32_dpp v136, v128, v128 row_ror:8 row_mask:0xf bank_mask:0x3
  v_dot2_f32_bf16 v129, v164, v216, 0
  v_dot2_f32_bf16 v133, v164, v164, 0
  v_dot2_f32_bf16 v129, v165, v216, v129
  v_dot2_f32_bf16 v133, v165, v165, v133
  v_dot2_f32_bf16 v129, v166, v216, v129
  v_dot2_f32_bf16 v133, v166, v166, v133
  v_dot2_f32_bf16 v129, v167, v216, v129
  v_dot2_f32_bf16 v133, v167, v167, v133
  v_add_f32_dpp v136, v132, v132 row_ror:8 row_mask:0xf bank_mask:0xc
  s_waitcnt vmcnt(1)
  v_dot2_f32_bf16 v152, v68, s57, v144
  v_dot2_f32_bf16 v153, v68, s58, v145
  v_dot2_f32_bf16 v154, v69, s57, v146
  v_dot2_f32_bf16 v155, v69, s58, v147
  v_dot2_f32_bf16 v156, v70, s57, v148
  v_dot2_f32_bf16 v157, v70, s58, v149
  v_dot2_f32_bf16 v158, v71, s57, v150
  v_dot2_f32_bf16 v159, v71, s58, v151
  v_cvt_pk_bf16_f32 v160, v152, v153
  v_cvt_pk_bf16_f32 v161, v154, v155
  v_cvt_pk_bf16_f32 v162, v156, v157
  v_cvt_pk_bf16_f32 v163, v158, v159
  ds_write_b128 v253, v[160:163] offset:1536
  v_add_f32_dpp v137, v129, v129 row_ror:8 row_mask:0xf bank_mask:0x3
  v_dot2_f32_bf16 v130, v160, v216, 0
  v_dot2_f32_bf16 v134, v160, v160, 0
  v_dot2_f32_bf16 v130, v161, v216, v130
  v_dot2_f32_bf16 v134, v161, v161, v134
  v_dot2_f32_bf16 v130, v162, v216, v130
  v_dot2_f32_bf16 v134, v162, v162, v134
  v_dot2_f32_bf16 v130, v163, v216, v130
  v_dot2_f32_bf16 v134, v163, v163, v134
  v_add_f32_dpp v137, v133, v133 row_ror:8 row_mask:0xf bank_mask:0xc
  s_waitcnt vmcnt(0)
  v_dot2_f32_bf16 v152, v72, s57, v144
  v_dot2_f32_bf16 v153, v72, s58, v145
  v_dot2_f32_bf16 v154, v73, s57, v146
  v_dot2_f32_bf16 v155, v73, s58, v147
  v_dot2_f32_bf16 v156, v74, s57, v148
  v_dot2_f32_bf16 v157, v74, s58, v149
  v_dot2_f32_bf16 v158, v75, s57, v150
  v_dot2_f32_bf16 v159, v75, s58, v151
  v_cvt_pk_bf16_f32 v164, v152, v153
  v_cvt_pk_bf16_f32 v165, v154, v155
  v_cvt_pk_bf16_f32 v166, v156, v157
  v_cvt_pk_bf16_f32 v167, v158, v159
  ds_write_b128 v254, v[164:167] offset:2304
  v_add_f32_dpp v138, v130, v130 row_ror:8 row_mask:0xf bank_mask:0x3
  v_dot2_f32_bf16 v131, v164, v216, 0
  v_dot2_f32_bf16 v135, v164, v164, 0
  v_dot2_f32_bf16 v131, v165, v216, v131
  v_dot2_f32_bf16 v135, v165, v165, v135
  v_dot2_f32_bf16 v131, v166, v216, v131
  v_dot2_f32_bf16 v135, v166, v166, v135
  v_dot2_f32_bf16 v131, v167, v216, v131
  v_dot2_f32_bf16 v135, v167, v167, v135
  v_add_f32_dpp v138, v134, v134 row_ror:8 row_mask:0xf bank_mask:0xc
  s_mov_b32 s62, 24576
  s_cmp_eq_u32 s66, 5
  s_cselect_b32 s62, 0xfffe2000, s62
  v_add_f32_dpp v140, v136, v136 row_half_mirror row_mask:0xf bank_mask:0x5
  v_add_f32_dpp v139, v131, v131 row_ror:8 row_mask:0xf bank_mask:0x3
  v_add_u32 v4, s62, v4
  v_add_f32_dpp v140, v137, v137 row_half_mirror row_mask:0xf bank_mask:0xa
  v_add_f32_dpp v139, v135, v135 row_ror:8 row_mask:0xf bank_mask:0xc
  v_add_f32_dpp v141, v138, v138 row_half_mirror row_mask:0xf bank_mask:0x5
  v_add_u32 v5, s62, v5
  v_add_f32_dpp v140, v140, v140 quad_perm:[1,0,3,2] row_mask:0xf bank_mask:0xf
  v_add_f32_dpp v141, v139, v139 row_half_mirror row_mask:0xf bank_mask:0xa
  v_add_u32 v253, s62, v253
  v_add_f32_dpp v140, v140, v140 quad_perm:[2,3,0,1] row_mask:0xf bank_mask:0xf
  v_add_f32_dpp v141, v141, v141 quad_perm:[1,0,3,2] row_mask:0xf bank_mask:0xf
  v_add_u32 v254, s62, v254
  s_mov_b32 s62, 768
  v_add_f32_dpp v141, v141, v141 quad_perm:[2,3,0,1] row_mask:0xf bank_mask:0xf
  s_mov_b64 exec, s[50:51]
  ds_write_b32 v255, v140
  ds_write_b32 v255, v141 offset:8
  s_mov_b64 exec, -1
  s_add_u32 s66, s66, 1
  v_add_u32 v255, s62, v255
  s_setpc_b64 s[68:69]
L_fuseR0:
  s_waitcnt vmcnt(14)
  v_lshlrev_b32 v144, 16, v16
  v_and_b32 v145, 0xffff0000, v16
  v_lshlrev_b32 v146, 16, v17
  v_and_b32 v147, 0xffff0000, v17
  v_lshlrev_b32 v148, 16, v18
  v_and_b32 v149, 0xffff0000, v18
  v_lshlrev_b32 v150, 16, v19
  v_and_b32 v151, 0xffff0000, v19
  s_waitcnt vmcnt(13)
  v_dot2_f32_bf16 v152, v20, s57, v144
  v_dot2_f32_bf16 v153, v20, s58, v145
  v_dot2_f32_bf16 v154, v21, s57, v146
  v_dot2_f32_bf16 v155, v21, s58, v147
  v_dot2_f32_bf16 v156, v22, s57, v148
  v_dot2_f32_bf16 v157, v22, s58, v149
  v_dot2_f32_bf16 v158, v23, s57, v150
  v_dot2_f32_bf16 v159, v23, s58, v151
  v_cvt_pk_bf16_f32 v160, v152, v153
  v_cvt_pk_bf16_f32 v161, v154, v155
  v_cvt_pk_bf16_f32 v162, v156, v157
  v_cvt_pk_bf16_f32 v163, v158, v159
  ds_write_b128 v4, v[160:163] offset:0
  v_dot2_f32_bf16 v128, v160, v216, 0
  v_dot2_f32_bf16 v132, v160, v160, 0
  v_dot2_f32_bf16 v128, v161, v216, v128
  v_dot2_f32_bf16 v132, v161, v161, v132
  v_dot2_f32_bf16 v128, v162, v216, v128
  v_dot2_f32_bf16 v132, v162, v162, v132
  v_dot2_f32_bf16 v128, v163, v216, v128
  v_dot2_f32_bf16 v132, v163, v163, v132
  s_waitcnt vmcnt(12)
  v_dot2_f32_bf16 v152, v24, s57, v144
  v_dot2_f32_bf16 v153, v24, s58, v145
  v_dot2_f32_bf16 v154, v25, s57, v146
  v_dot2_f32_bf16 v155, v25, s58, v147
  v_dot2_f32_bf16 v156, v26, s57, v148
  v_dot2_f32_bf16 v157, v26, s58, v149
  v_dot2_f32_bf16 v158, v27, s57, v150
  v_dot2_f32_bf16 v159, v27, s58, v151
  v_cvt_pk_bf16_f32 v164, v152, v153
  v_cvt_pk_bf16_f32 v165, v154, v155
  v_cvt_pk_bf16_f32 v166, v156, v157
  v_cvt_pk_bf16_f32 v167, v158, v159
  ds_write_b128 v5, v[164:167] offset:768
  v_add_f32_dpp v136, v128, v128 row_ror:8 row_mask:0xf bank_mask:0x3
  v_dot2_f32_bf16 v129, v164, v216, 0
  v_dot2_f32_bf16 v133, v164, v164, 0
  v_dot2_f32_bf16 v129, v165, v216, v129
  v_dot2_f32_bf16 v133, v165, v165, v133
  v_dot2_f32_bf16 v129, v166, v216, v129
  v_dot2_f32_bf16 v133, v166, v166, v133
  v_dot2_f32_bf16 v129, v167, v216, v129
  v_dot2_f32_bf16 v133, v167, v167, v133
  v_add_f32_dpp v136, v132, v132 row_ror:8 row_mask:0xf bank_mask:0xc
  s_waitcnt vmcnt(11)
  v_dot2_f32_bf16 v152, v28, s57, v144
  v_dot2_f32_bf16 v153, v28, s58, v145
  v_dot2_f32_bf16 v154, v29, s57, v146
  v_dot2_f32_bf16 v155, v29, s58, v147
  v_dot2_f32_bf16 v156, v30, s57, v148
  v_dot2_f32_bf16 v157, v30, s58, v149
  v_dot2_f32_bf16 v158, v31, s57, v150
  v_dot2_f32_bf16 v159, v31, s58, v151
  v_cvt_pk_bf16_f32 v160, v152, v153
  v_cvt_pk_bf16_f32 v161, v154, v155
  v_cvt_pk_bf16_f32 v162, v156, v157
  v_cvt_pk_bf16_f32 v163, v158, v159
  ds_write_b128 v253, v[160:163] offset:1536
  v_add_f32_dpp v137, v129, v129 row_ror:8 row_mask:0xf bank_mask:0x3
  v_dot2_f32_bf16 v130, v160, v216, 0
  v_dot2_f32_bf16 v134, v160, v160, 0
  v_dot2_f32_bf16 v130, v161, v216, v130
  v_dot2_f32_bf16 v134, v161, v161, v134
  v_dot2_f32_bf16 v130, v162, v216, v130
  v_dot2_f32_bf16 v134, v162, v162, v134
  v_dot2_f32_bf16 v130, v163, v216, v130
  v_dot2_f32_bf16 v134, v163, v163, v134
  v_add_f32_dpp v137, v133, v133 row_ror:8 row_mask:0xf bank_mask:0xc
  s_waitcnt vmcnt(10)
  v_dot2_f32_bf16 v152, v32, s57, v144
  v_dot2_f32_bf16 v153, v32, s58, v145
  v_dot2_f32_bf16 v154, v33, s57, v146
  v_dot2_f32_bf16 v155, v33, s58, v147
  v_dot2_f32_bf16 v156, v34, s57, v148
  v_dot2_f32_bf16 v157, v34, s58, v149
  v_dot2_f32_bf16 v158, v35, s57, v150
  v_dot2_f32_bf16 v159, v35, s58, v151
  v_cvt_pk_bf16_f32 v164, v152, v153
  v_cvt_pk_bf16_f32 v165, v154, v155
  v_cvt_pk_bf16_f32 v166, v156, v157
  v_cvt_pk_bf16_f32 v167, v158, v159
  ds_write_b128 v254, v[164:167] offset:2304
  v_add_f32_dpp v138, v130, v130 row_ror:8 row_mask:0xf bank_mask:0x3
  v_dot2_f32_bf16 v131, v164, v216, 0
  v_dot2_f32_bf16 v135, v164, v164, 0
  v_dot2_f32_bf16 v131, v165, v216, v131
  v_dot2_f32_bf16 v135, v165, v165, v135
  v_dot2_f32_bf16 v131, v166, v216, v131
  v_dot2_f32_bf16 v135, v166, v166, v135
  v_dot2_f32_bf16 v131, v167, v216, v131
  v_dot2_f32_bf16 v135, v167, v167, v135
  v_add_f32_dpp v138, v134, v134 row_ror:8 row_mask:0xf bank_mask:0xc
  s_mov_b32 s62, 24576
  s_cmp_eq_u32 s66, 5
  s_cselect_b32 s62, 0xfffe2000, s62
  v_add_f32_dpp v140, v136, v136 row_half_mirror row_mask:0xf bank_mask:0x5
  v_add_f32_dpp v139, v131, v131 row_ror:8 row_mask:0xf bank_mask:0x3
  v_add_u32 v4, s62, v4
  v_add_f32_dpp v140, v137, v137 row_half_mirror row_mask:0xf bank_mask:0xa
  v_add_f32_dpp v139, v135, v135 row_ror:8 row_mask:0xf bank_mask:0xc
  v_add_f32_dpp v141, v138, v138 row_half_mirror row_mask:0xf bank_mask:0x5
  v_add_u32 v5, s62, v5
  v_add_f32_dpp v140, v140, v140 quad_perm:[1,0,3,2] row_mask:0xf bank_mask:0xf
  v_add_f32_dpp v141, v139, v139 row_half_mirror row_mask:0xf bank_mask:0xa
  v_add_u32 v253, s62, v253
  v_add_f32_dpp v140, v140, v140 quad_perm:[2,3,0,1] row_mask:0xf bank_mask:0xf
  v_add_f32_dpp v141, v141, v141 quad_perm:[1,0,3,2] row_mask:0xf bank_mask:0xf
  v_add_u32 v254, s62, v254
  s_mov_b32 s62, 768
  v_add_f32_dpp v141, v141, v141 quad_perm:[2,3,0,1] row_mask:0xf bank_mask:0xf
  s_mov_b64 exec, s[50:51]
  ds_write_b32 v255, v140
  ds_write_b32 v255, v141 offset:8
  s_mov_b64 exec, -1
  s_add_u32 s66, s66, 1
  v_add_u32 v255, s62, v255
  s_setpc_b64 s[68:69]
L_fuse0:
  s_mov_b32 s40, s44
  s_mov_b32 s41, s45
  s_mov_b32 s42, s46
  s_add_u32 s62, s66, 1
  s_lshl_b32 s63, s62, 1
  s_add_u32 s63, s63, s67
  s_mul_i32 s44, s63, 3072
  s_lshr_b32 s64, s63, 5
  s_mul_i32 s64, s64, 393216
  s_and_b32 s65, s63, 31
  s_mul_i32 s65, s65, 6144
  s_add_u32 s45, s64, s65
  s_cmp_gt_u32 s62, 8
  s_cselect_b32 s44, 0x80000000, s44
  s_cselect_b32 s45, 0x80000000, s45
  s_add_u32 s46, s45, 196608
  s_waitcnt vmcnt(3)
  v_lshlrev_b32 v144, 16, v16
  v_and_b32 v145, 0xffff0000, v16
  v_lshlrev_b32 v146, 16, v17
  v_and_b32 v147, 0xffff0000, v17
  v_lshlrev_b32 v148, 16, v18
  v_and_b32 v149, 0xffff0000, v18
  v_lshlrev_b32 v150, 16, v19
  v_and_b32 v151, 0xffff0000, v19
  buffer_load_dwordx4 v[32:35], v3, s[24:27], s42 offen offset:768 nt
  s_waitcnt vmcnt(3)
  v_dot2_f32_bf16 v152, v20, s57, v144
  v_dot2_f32_bf16 v153, v20, s58, v145
  v_dot2_f32_bf16 v154, v21, s57, v146
  v_dot2_f32_bf16 v155, v21, s58, v147
  v_dot2_f32_bf16 v156, v22, s57, v148
  v_dot2_f32_bf16 v157, v22, s58, v149
  v_dot2_f32_bf16 v158, v23, s57, v150
  v_dot2_f32_bf16 v159, v23, s58, v151
  buffer_load_dwordx4 v[36:39], v2, s[28:31], s44 offen nt
  v_cvt_pk_bf16_f32 v160, v152, v153
  v_cvt_pk_bf16_f32 v161, v154, v155
  v_cvt_pk_bf16_f32 v162, v156, v157
  v_cvt_pk_bf16_f32 v163, v158, v159
  ds_write_b128 v4, v[160:163] offset:0
  v_dot2_f32_bf16 v128, v160, v216, 0
  v_dot2_f32_bf16 v132, v160, v160, 0
  v_dot2_f32_bf16 v128, v161, v216, v128
  v_dot2_f32_bf16 v132, v161, v161, v132
  v_dot2_f32_bf16 v128, v162, v216, v128
  v_dot2_f32_bf16 v132, v162, v162, v132
  v_dot2_f32_bf16 v128, v163, v216, v128
  v_dot2_f32_bf16 v132, v163, v163, v132
  s_waitcnt vmcnt(3)
  v_dot2_f32_bf16 v152, v24, s57, v144
  v_dot2_f32_bf16 v153, v24, s58, v145
  v_dot2_f32_bf16 v154, v25, s57, v146
  v_dot2_f32_bf16 v155, v25, s58, v147
  v_dot2_f32_bf16 v156, v26, s57, v148
  v_dot2_f32_bf16 v157, v26, s58, v149
  v_dot2_f32_bf16 v158, v27, s57, v150
  v_dot2_f32_bf16 v159, v27, s58, v151
  buffer_load_dwordx4 v[40:43], v3, s[24:27], s45 offen nt
  v_cvt_pk_bf16_f32 v164, v152, v153
  v_cvt_pk_bf16_f32 v165, v154, v155
  v_cvt_pk_bf16_f32 v166, v156, v157
  v_cvt_pk_bf16_f32 v167, v158, v159
  ds_write_b128 v5, v[164:167] offset:768
  v_add_f32_dpp v136, v128, v128 row_ror:8 row_mask:0xf bank_mask:0x3
  v_dot2_f32_bf16 v129, v164, v216, 0
  v_dot2_f32_bf16 v133, v164, v164, 0
  v_dot2_f32_bf16 v129, v165, v216, v129
  v_dot2_f32_bf16 v133, v165, v165, v133
  v_dot2_f32_bf16 v129, v166, v216, v129
  v_dot2_f32_bf16 v133, v166, v166, v133
  v_dot2_f32_bf16 v129, v167, v216, v129
  v_dot2_f32_bf16 v133, v167, v167, v133
  v_add_f32_dpp v136, v132, v132 row_ror:8 row_mask:0xf bank_mask:0xc
  s_waitcnt vmcnt(3)
  v_dot2_f32_bf16 v152, v28, s57, v144
  v_dot2_f32_bf16 v153, v28, s58, v145
  v_dot2_f32_bf16 v154, v29, s57, v146
  v_dot2_f32_bf16 v155, v29, s58, v147
  v_dot2_f32_bf16 v156, v30, s57, v148
  v_dot2_f32_bf16 v157, v30, s58, v149
  v_dot2_f32_bf16 v158, v31, s57, v150
  v_dot2_f32_bf16 v159, v31, s58, v151
  buffer_load_dwordx4 v[44:47], v3, s[24:27], s45 offen offset:768 nt
  v_cvt_pk_bf16_f32 v160, v152, v153
  v_cvt_pk_bf16_f32 v161, v154, v155
  v_cvt_pk_bf16_f32 v162, v156, v157
  v_cvt_pk_bf16_f32 v163, v158, v159
  ds_write_b128 v253, v[160:163] offset:1536
  v_add_f32_dpp v137, v129, v129 row_ror:8 row_mask:0xf bank_mask:0x3
  v_dot2_f32_bf16 v130, v160, v216, 0
  v_dot2_f32_bf16 v134, v160, v160, 0
  v_dot2_f32_bf16 v130, v161, v216, v130
  v_dot2_f32_bf16 v134, v161, v161, v134
  v_dot2_f32_bf16 v130, v162, v216, v130
  v_dot2_f32_bf16 v134, v162, v162, v134
  v_dot2_f32_bf16 v130, v163, v216, v130
  v_dot2_f32_bf16 v134, v163, v163, v134
  v_add_f32_dpp v137, v133, v133 row_ror:8 row_mask:0xf bank_mask:0xc
  s_waitcnt vmcnt(3)
  v_dot2_f32_bf16 v152, v32, s57, v144
  v_dot2_f32_bf16 v153, v32, s58, v145
  v_dot2_f32_bf16 v154, v33, s57, v146
  v_dot2_f32_bf16 v155, v33, s58, v147
  v_dot2_f32_bf16 v156, v34, s57, v148
  v_dot2_f32_bf16 v157, v34, s58, v149
  v_dot2_f32_bf16 v158, v35, s57, v150
  v_dot2_f32_bf16 v159, v35, s58, v151
  buffer_load_dwordx4 v[48:51], v3, s[24:27], s46 offen nt
  v_cvt_pk_bf16_f32 v164, v152, v153
  v_cvt_pk_bf16_f32 v165, v154, v155
  v_cvt_pk_bf16_f32 v166, v156, v157
  v_cvt_pk_bf16_f32 v167, v158, v159
  ds_write_b128 v254, v[164:167] offset:2304
  v_add_f32_dpp v138, v130, v130 row_ror:8 row_mask:0xf bank_mask:0x3
  v_dot2_f32_bf16 v131, v164, v216, 0
  v_dot2_f32_bf16 v135, v164, v164, 0
  v_dot2_f32_bf16 v131, v165, v216, v131
  v_dot2_f32_bf16 v135, v165, v165, v135
  v_dot2_f32_bf16 v131, v166, v216, v131
  v_dot2_f32_bf16 v135, v166, v166, v135
  v_dot2_f32_bf16 v131, v167, v216, v131
  v_dot2_f32_bf16 v135, v167, v167, v135
  v_add_f32_dpp v138, v134, v134 row_ror:8 row_mask:0xf bank_mask:0xc
  s_mov_b32 s62, 24576
  s_cmp_eq_u32 s66, 5
  s_cselect_b32 s62, 0xfffe2000, s62
  v_add_f32_dpp v140, v136, v136 row_half_mirror row_mask:0xf bank_mask:0x5
  v_add_f32_dpp v139, v131, v131 row_ror:8 row_mask:0xf bank_mask:0x3
  v_add_u32 v4, s62, v4
  v_add_f32_dpp v140, v137, v137 row_half_mirror row_mask:0xf bank_mask:0xa
  v_add_f32_dpp v139, v135, v135 row_ror:8 row_mask:0xf bank_mask:0xc
  v_add_f32_dpp v141, v138, v138 row_half_mirror row_mask:0xf bank_mask:0x5
  v_add_u32 v5, s62, v5
  v_add_f32_dpp v140, v140, v140 quad_perm:[1,0,3,2] row_mask:0xf bank_mask:0xf
  v_add_f32_dpp v141, v139, v139 row_half_mirror row_mask:0xf bank_mask:0xa
  v_add_u32 v253, s62, v253
  v_add_f32_dpp v140, v140, v140 quad_perm:[2,3,0,1] row_mask:0xf bank_mask:0xf
  v_add_f32_dpp v141, v141, v141 quad_perm:[1,0,3,2] row_mask:0xf bank_mask:0xf
  v_add_u32 v254, s62, v254
  s_mov_b32 s63, 768
  s_cmp_eq_u32 s66, 5
  s_cselect_b32 s62, 0xfffff100, s63
  v_add_f32_dpp v141, v141, v141 quad_perm:[2,3,0,1] row_mask:0xf bank_mask:0xf
  s_cbranch_scc1 L_keepst_21
  s_mov_b64 exec, s[50:51]
  ds_write_b32 v255, v140
  ds_write_b32 v255, v141 offset:8
  s_mov_b64 exec, -1
L_keepst_21:
  s_add_u32 s66, s66, 1
  v_add_u32 v255, s62, v255
  s_setpc_b64 s[68:69]
L_fuse1:
  s_mov_b32 s40, s44
  s_mov_b32 s41, s45
  s_mov_b32 s42, s46
  s_add_u32 s62, s66, 1
  s_lshl_b32 s63, s62, 1
  s_add_u32 s63, s63, s67
  s_mul_i32 s44, s63, 3072
  s_lshr_b32 s64, s63, 5
  s_mul_i32 s64, s64, 393216
  s_and_b32 s65, s63, 31
  s_mul_i32 s65, s65, 6144
  s_add_u32 s45, s64, s65
  s_cmp_gt_u32 s62, 8
  s_cselect_b32 s44, 0x80000000, s44
  s_cselect_b32 s45, 0x80000000, s45
  s_add_u32 s46, s45, 196608
  s_waitcnt vmcnt(3)
  v_lshlrev_b32 v144, 16, v36
  v_and_b32 v145, 0xffff0000, v36
  v_lshlrev_b32 v146, 16, v37
  v_and_b32 v147, 0xffff0000, v37
  v_lshlrev_b32 v148, 16, v38
  v_and_b32 v149, 0xffff0000, v38
  v_lshlrev_b32 v150, 16, v39
  v_and_b32 v151, 0xffff0000, v39
  buffer_load_dwordx4 v[52:55], v3, s[24:27], s42 offen offset:768 nt
  s_waitcnt vmcnt(3)
  v_dot2_f32_bf16 v152, v40, s57, v144
  v_dot2_f32_bf16 v153, v40, s58, v145
  v_dot2_f32_bf16 v154, v41, s57, v146
  v_dot2_f32_bf16 v155, v41, s58, v147
  v_dot2_f32_bf16 v156, v42, s57, v148
  v_dot2_f32_bf16 v157, v42, s58, v149
  v_dot2_f32_bf16 v158, v43, s57, v150
  v_dot2_f32_bf16 v159, v43, s58, v151
  buffer_load_dwordx4 v[16:19], v2, s[28:31], s44 offen nt
  v_cvt_pk_bf16_f32 v160, v152, v153
  v_cvt_pk_bf16_f32 v161, v154, v155
  v_cvt_pk_bf16_f32 v162, v156, v157
  v_cvt_pk_bf16_f32 v163, v158, v159
  ds_write_b128 v4, v[160:163] offset:0
  v_dot2_f32_bf16 v128, v160, v216, 0
  v_dot2_f32_bf16 v132, v160, v160, 0
  v_dot2_f32_bf16 v128, v161, v216, v128
  v_dot2_f32_bf16 v132, v161, v161, v132
  v_dot2_f32_bf16 v128, v162, v216, v128
  v_dot2_f32_bf16 v132, v162, v162, v132
  v_dot2_f32_bf16 v128, v163, v216, v128
  v_dot2_f32_bf16 v132, v163, v163, v132
  s_waitcnt vmcnt(3)
  v_dot2_f32_bf16 v152, v44, s57, v144
  v_dot2_f32_bf16 v153, v44, s58, v145
  v_dot2_f32_bf16 v154, v45, s57, v146
  v_dot2_f32_bf16 v155, v45, s58, v147
  v_dot2_f32_bf16 v156, v46, s57, v148
  v_dot2_f32_bf16 v157, v46, s58, v149
  v_dot2_f32_bf16 v158, v47, s57, v150
  v_dot2_f32_bf16 v159, v47, s58, v151
  buffer_load_dwordx4 v[20:23], v3, s[24:27], s45 offen nt
  v_cvt_pk_bf16_f32 v164, v152, v153
  v_cvt_pk_bf16_f32 v165, v154, v155
  v_cvt_pk_bf16_f32 v166, v156, v157
  v_cvt_pk_bf16_f32 v167, v158, v159
  ds_write_b128 v5, v[164:167] offset:768
  v_add_f32_dpp v136, v128, v128 row_ror:8 row_mask:0xf bank_mask:0x3
  v_dot2_f32_bf16 v129, v164, v216, 0
  v_dot2_f32_bf16 v133, v164, v164, 0
  v_dot2_f32_bf16 v129, v165, v216, v129
  v_dot2_f32_bf16 v133, v165, v165, v133
  v_dot2_f32_bf16 v129, v166, v216, v129
  v_dot2_f32_bf16 v133, v166, v166, v133
  v_dot2_f32_bf16 v129, v167, v216, v129
  v_dot2_f32_bf16 v133, v167, v167, v133
  v_add_f32_dpp v136, v132, v132 row_ror:8 row_mask:0xf bank_mask:0xc
  s_waitcnt vmcnt(3)
  v_dot2_f32_bf16 v152, v48, s57, v144
  v_dot2_f32_bf16 v153, v48, s58, v145
  v_dot2_f32_bf16 v154, v49, s57, v146
  v_dot2_f32_bf16 v155, v49, s58, v147
  v_dot2_f32_bf16 v156, v50, s57, v148
  v_dot2_f32_bf16 v157, v50, s58, v149
  v_dot2_f32_bf16 v158, v51, s57, v150
  v_dot2_f32_bf16 v159, v51, s58, v151
  buffer_load_dwordx4 v[24:27], v3, s[24:27], s45 offen offset:768 nt
  v_cvt_pk_bf16_f32 v160, v152, v153
  v_cvt_pk_bf16_f32 v161, v154, v155
  v_cvt_pk_bf16_f32 v162, v156, v157
  v_cvt_pk_bf16_f32 v163, v158, v159
  ds_write_b128 v253, v[160:163] offset:1536
  v_add_f32_dpp v137, v129, v129 row_ror:8 row_mask:0xf bank_mask:0x3
  v_dot2_f32_bf16 v130, v160, v216, 0
  v_dot2_f32_bf16 v134, v160, v160, 0
  v_dot2_f32_bf16 v130, v161, v216, v130
  v_dot2_f32_bf16 v134, v161, v161, v134
  v_dot2_f32_bf16 v130, v162, v216, v130
  v_dot2_f32_bf16 v134, v162, v162, v134
  v_dot2_f32_bf16 v130, v163, v216, v130
  v_dot2_f32_bf16 v134, v163, v163, v134
  v_add_f32_dpp v137, v133, v133 row_ror:8 row_mask:0xf bank_mask:0xc
  s_waitcnt vmcnt(3)
  v_dot2_f32_bf16 v152, v52, s57, v144
  v_dot2_f32_bf16 v153, v52, s58, v145
  v_dot2_f32_bf16 v154, v53, s57, v146
  v_dot2_f32_bf16 v155, v53, s58, v147
  v_dot2_f32_bf16 v156, v54, s57, v148
  v_dot2_f32_bf16 v157, v54, s58, v149
  v_dot2_f32_bf16 v158, v55, s57, v150
  v_dot2_f32_bf16 v159, v55, s58, v151
  buffer_load_dwordx4 v[28:31], v3, s[24:27], s46 offen nt
  v_cvt_pk_bf16_f32 v164, v152, v153
  v_cvt_pk_bf16_f32 v165, v154, v155
  v_cvt_pk_bf16_f32 v166, v156, v157
  v_cvt_pk_bf16_f32 v167, v158, v159
  ds_write_b128 v254, v[164:167] offset:2304
  v_add_f32_dpp v138, v130, v130 row_ror:8 row_mask:0xf bank_mask:0x3
  v_dot2_f32_bf16 v131, v164, v216, 0
  v_dot2_f32_bf16 v135, v164, v164, 0
  v_dot2_f32_bf16 v131, v165, v216, v131
  v_dot2_f32_bf16 v135, v165, v165, v135
  v_dot2_f32_bf16 v131, v166, v216, v131
  v_dot2_f32_bf16 v135, v166, v166, v135
  v_dot2_f32_bf16 v131, v167, v216, v131
  v_dot2_f32_bf16 v135, v167, v167, v135
  v_add_f32_dpp v138, v134, v134 row_ror:8 row_mask:0xf bank_mask:0xc
  s_mov_b32 s62, 24576
  s_cmp_eq_u32 s66, 5
  s_cselect_b32 s62, 0xfffe2000, s62
  v_add_f32_dpp v140, v136, v136 row_half_mirror row_mask:0xf bank_mask:0x5
  v_add_f32_dpp v139, v131, v131 row_ror:8 row_mask:0xf bank_mask:0x3
  v_add_u32 v4, s62, v4
  v_add_f32_dpp v140, v137, v137 row_half_mirror row_mask:0xf bank_mask:0xa
  v_add_f32_dpp v139, v135, v135 row_ror:8 row_mask:0xf bank_mask:0xc
  v_add_f32_dpp v141, v138, v138 row_half_mirror row_mask:0xf bank_mask:0x5
  v_add_u32 v5, s62, v5
  v_add_f32_dpp v140, v140, v140 quad_perm:[1,0,3,2] row_mask:0xf bank_mask:0xf
  v_add_f32_dpp v141, v139, v139 row_half_mirror row_mask:0xf bank_mask:0xa
  v_add_u32 v253, s62, v253
  v_add_f32_dpp v140, v140, v140 quad_perm:[2,3,0,1] row_mask:0xf bank_mask:0xf
  v_add_f32_dpp v141, v141, v141 quad_perm:[1,0,3,2] row_mask:0xf bank_mask:0xf
  v_add_u32 v254, s62, v254
  s_mov_b32 s63, 768
  s_cmp_eq_u32 s66, 5
  s_cselect_b32 s62, 0xfffff100, s63
  v_add_f32_dpp v141, v141, v141 quad_perm:[2,3,0,1] row_mask:0xf bank_mask:0xf
  s_cbranch_scc1 L_keepst_22
  s_mov_b64 exec, s[50:51]
  ds_write_b32 v255, v140
  ds_write_b32 v255, v141 offset:8
  s_mov_b64 exec, -1
L_keepst_22:
  s_add_u32 s66, s66, 1
  v_add_u32 v255, s62, v255
  s_setpc_b64 s[68:69]
L_fuseL0:
  s_mov_b32 s40, s44
  s_mov_b32 s41, s45
  s_mov_b32 s42, s46
  s_add_u32 s62, s66, 2
  s_lshl_b32 s63, s62, 1
  s_add_u32 s63, s63, s67
  s_mul_i32 s44, s63, 3072
  s_lshr_b32 s64, s63, 5
  s_mul_i32 s64, s64, 393216
  s_and_b32 s65, s63, 31
  s_mul_i32 s65, s65, 6144
  s_add_u32 s45, s64, s65
  s_cmp_gt_u32 s62, 8
  s_cselect_b32 s44, 0x80000000, s44
  s_cselect_b32 s45, 0x80000000, s45
  s_add_u32 s46, s45, 196608
  s_waitcnt vmcnt(4)
  v_lshlrev_b32 v144, 16, v16
  v_and_b32 v145, 0xffff0000, v16
  v_lshlrev_b32 v146, 16, v17
  v_and_b32 v147, 0xffff0000, v17
  v_lshlrev_b32 v148, 16, v18
  v_and_b32 v149, 0xffff0000, v18
  v_lshlrev_b32 v150, 16, v19
  v_and_b32 v151, 0xffff0000, v19
  buffer_load_dwordx4 v[36:39], v2, s[28:31], s40 offen nt
  s_waitcnt vmcnt(4)
  v_dot2_f32_bf16 v152, v20, s57, v144
  v_dot2_f32_bf16 v153, v20, s58, v145
  v_dot2_f32_bf16 v154, v21, s57, v146
  v_dot2_f32_bf16 v155, v21, s58, v147
  v_dot2_f32_bf16 v156, v22, s57, v148
  v_dot2_f32_bf16 v157, v22, s58, v149
  v_dot2_f32_bf16 v158, v23, s57, v150
  v_dot2_f32_bf16 v159, v23, s58, v151
  buffer_load_dwordx4 v[40:43], v3, s[24:27], s41 offen nt
  v_cvt_pk_bf16_f32 v160, v152, v153
  v_cvt_pk_bf16_f32 v161, v154, v155
  v_cvt_pk_bf16_f32 v162, v156, v157
  v_cvt_pk_bf16_f32 v163, v158, v159
  ds_write_b128 v4, v[160:163] offset:0
  v_dot2_f32_bf16 v128, v160, v216, 0
  v_dot2_f32_bf16 v132, v160, v160, 0
  v_dot2_f32_bf16 v128, v161, v216, v128
  v_dot2_f32_bf16 v132, v161, v161, v132
  v_dot2_f32_bf16 v128, v162, v216, v128
  v_dot2_f32_bf16 v132, v162, v162, v132
  v_dot2_f32_bf16 v128, v163, v216, v128
  v_dot2_f32_bf16 v132, v163, v163, v132
  s_waitcnt vmcnt(4)
  v_dot2_f32_bf16 v152, v24, s57, v144
  v_dot2_f32_bf16 v153, v24, s58, v145
  v_dot2_f32_bf16 v154, v25, s57, v146
  v_dot2_f32_bf16 v155, v25, s58, v147
  v_dot2_f32_bf16 v156, v26, s57, v148
  v_dot2_f32_bf16 v157, v26, s58, v149
  v_dot2_f32_bf16 v158, v27, s57, v150
  v_dot2_f32_bf16 v159, v27, s58, v151
  buffer_load_dwordx4 v[44:47], v3, s[24:27], s41 offen offset:768 nt
  v_cvt_pk_bf16_f32 v164, v152, v153
  v_cvt_pk_bf16_f32 v165, v154, v155
  v_cvt_pk_bf16_f32 v166, v156, v157
  v_cvt_pk_bf16_f32 v167, v158, v159
  ds_write_b128 v5, v[164:167] offset:768
  v_add_f32_dpp v136, v128, v128 row_ror:8 row_mask:0xf bank_mask:0x3
  v_dot2_f32_bf16 v129, v164, v216, 0
  v_dot2_f32_bf16 v133, v164, v164, 0
  v_dot2_f32_bf16 v129, v165, v216, v129
  v_dot2_f32_bf16 v133, v165, v165, v133
  v_dot2_f32_bf16 v129, v166, v216, v129
  v_dot2_f32_bf16 v133, v166, v166, v133
  v_dot2_f32_bf16 v129, v167, v216, v129
  v_dot2_f32_bf16 v133, v167, v167, v133
  v_add_f32_dpp v136, v132, v132 row_ror:8 row_mask:0xf bank_mask:0xc
  s_waitcnt vmcnt(4)
  v_dot2_f32_bf16 v152, v28, s57, v144
  v_dot2_f32_bf16 v153, v28, s58, v145
  v_dot2_f32_bf16 v154, v29, s57, v146
  v_dot2_f32_bf16 v155, v29, s58, v147
  v_dot2_f32_bf16 v156, v30, s57, v148
  v_dot2_f32_bf16 v157, v30, s58, v149
  v_dot2_f32_bf16 v158, v31, s57, v150
  v_dot2_f32_bf16 v159, v31, s58, v151
  buffer_load_dwordx4 v[48:51], v3, s[24:27], s42 offen nt
  v_cvt_pk_bf16_f32 v160, v152, v153
  v_cvt_pk_bf16_f32 v161, v154, v155
  v_cvt_pk_bf16_f32 v162, v156, v157
  v_cvt_pk_bf16_f32 v163, v158, v159
  ds_write_b128 v253, v[160:163] offset:1536
  v_add_f32_dpp v137, v129, v129 row_ror:8 row_mask:0xf bank_mask:0x3
  v_dot2_f32_bf16 v130, v160, v216, 0
  v_dot2_f32_bf16 v134, v160, v160, 0
  v_dot2_f32_bf16 v130, v161, v216, v130
  v_dot2_f32_bf16 v134, v161, v161, v134
  v_dot2_f32_bf16 v130, v162, v216, v130
  v_dot2_f32_bf16 v134, v162, v162, v134
  v_dot2_f32_bf16 v130, v163, v216, v130
  v_dot2_f32_bf16 v134, v163, v163, v134
  v_add_f32_dpp v137, v133, v133 row_ror:8 row_mask:0xf bank_mask:0xc
  s_waitcnt vmcnt(4)
  v_dot2_f32_bf16 v152, v32, s57, v144
  v_dot2_f32_bf16 v153, v32, s58, v145
  v_dot2_f32_bf16 v154, v33, s57, v146
  v_dot2_f32_bf16 v155, v33, s58, v147
  v_dot2_f32_bf16 v156, v34, s57, v148
  v_dot2_f32_bf16 v157, v34, s58, v149
  v_dot2_f32_bf16 v158, v35, s57, v150
  v_dot2_f32_bf16 v159, v35, s58, v151
  buffer_load_dwordx4 v[52:55], v3, s[24:27], s42 offen offset:768 nt
  v_cvt_pk_bf16_f32 v164, v152, v153
  v_cvt_pk_bf16_f32 v165, v154, v155
  v_cvt_pk_bf16_f32 v166, v156, v157
  v_cvt_pk_bf16_f32 v167, v158, v159
  ds_write_b128 v254, v[164:167] offset:2304
  v_add_f32_dpp v138, v130, v130 row_ror:8 row_mask:0xf bank_mask:0x3
  v_dot2_f32_bf16 v131, v164, v216, 0
  v_dot2_f32_bf16 v135, v164, v164, 0
  v_dot2_f32_bf16 v131, v165, v216, v131
  v_dot2_f32_bf16 v135, v165, v165, v135
  v_dot2_f32_bf16 v131, v166, v216, v131
  v_dot2_f32_bf16 v135, v166, v166, v135
  v_dot2_f32_bf16 v131, v167, v216, v131
  v_dot2_f32_bf16 v135, v167, v167, v135
  v_add_f32_dpp v138, v134, v134 row_ror:8 row_mask:0xf bank_mask:0xc
  s_mov_b32 s62, 24576
  s_cmp_eq_u32 s66, 5
  s_cselect_b32 s62, 0xfffe2000, s62
  v_add_f32_dpp v140, v136, v136 row_half_mirror row_mask:0xf bank_mask:0x5
  v_add_f32_dpp v139, v131, v131 row_ror:8 row_mask:0xf bank_mask:0x3
  v_add_u32 v4, s62, v4
  v_add_f32_dpp v140, v137, v137 row_half_mirror row_mask:0xf bank_mask:0xa
  v_add_f32_dpp v139, v135, v135 row_ror:8 row_mask:0xf bank_mask:0xc
  v_add_f32_dpp v141, v138, v138 row_half_mirror row_mask:0xf bank_mask:0x5
  v_add_u32 v5, s62, v5
  v_add_f32_dpp v140, v140, v140 quad_perm:[1,0,3,2] row_mask:0xf bank_mask:0xf
  v_add_f32_dpp v141, v139, v139 row_half_mirror row_mask:0xf bank_mask:0xa
  v_add_u32 v253, s62, v253
  v_add_f32_dpp v140, v140, v140 quad_perm:[2,3,0,1] row_mask:0xf bank_mask:0xf
  v_add_f32_dpp v141, v141, v141 quad_perm:[1,0,3,2] row_mask:0xf bank_mask:0xf
  v_add_u32 v254, s62, v254
  s_mov_b32 s63, 768
  s_cmp_eq_u32 s66, 5
  s_cselect_b32 s62, 0xfffff100, s63
  v_add_f32_dpp v141, v141, v141 quad_perm:[2,3,0,1] row_mask:0xf bank_mask:0xf
  s_cbranch_scc1 L_keepst_23
  s_mov_b64 exec, s[50:51]
  ds_write_b32 v255, v140
  ds_write_b32 v255, v141 offset:8
  s_mov_b64 exec, -1
L_keepst_23:
  s_add_u32 s66, s66, 1
  v_add_u32 v255, s62, v255
  s_setpc_b64 s[68:69]
L_fuseL1:
  s_mov_b32 s40, s44
  s_mov_b32 s41, s45
  s_mov_b32 s42, s46
  s_add_u32 s62, s66, 2
  s_lshl_b32 s63, s62, 1
  s_add_u32 s63, s63, s67
  s_mul_i32 s44, s63, 3072
  s_lshr_b32 s64, s63, 5
  s_mul_i32 s64, s64, 393216
  s_and_b32 s65, s63, 31
  s_mul_i32 s65, s65, 6144
  s_add_u32 s45, s64, s65
  s_cmp_gt_u32 s62, 8
  s_cselect_b32 s44, 0x80000000, s44
  s_cselect_b32 s45, 0x80000000, s45
  s_add_u32 s46, s45, 196608
  s_waitcnt vmcnt(4)
  v_lshlrev_b32 v144, 16, v36
  v_and_b32 v145, 0xffff0000, v36
  v_lshlrev_b32 v146, 16, v37
  v_and_b32 v147, 0xffff0000, v37
  v_lshlrev_b32 v148, 16, v38
  v_and_b32 v149, 0xffff0000, v38
  v_lshlrev_b32 v150, 16, v39
  v_and_b32 v151, 0xffff0000, v39
  buffer_load_dwordx4 v[16:19], v2, s[28:31], s40 offen nt
  s_waitcnt vmcnt(4)
  v_dot2_f32_bf16 v152, v40, s57, v144
  v_dot2_f32_bf16 v153, v40, s58, v145
  v_dot2_f32_bf16 v154, v41, s57, v146
  v_dot2_f32_bf16 v155, v41, s58, v147
  v_dot2_f32_bf16 v156, v42, s57, v148
  v_dot2_f32_bf16 v157, v42, s58, v149
  v_dot2_f32_bf16 v158, v43, s57, v150
  v_dot2_f32_bf16 v159, v43, s58, v151
  buffer_load_dwordx4 v[20:23], v3, s[24:27], s41 offen nt
  v_cvt_pk_bf16_f32 v160, v152, v153
  v_cvt_pk_bf16_f32 v161, v154, v155
  v_cvt_pk_bf16_f32 v162, v156, v157
  v_cvt_pk_bf16_f32 v163, v158, v159
  ds_write_b128 v4, v[160:163] offset:0
  v_dot2_f32_bf16 v128, v160, v216, 0
  v_dot2_f32_bf16 v132, v160, v160, 0
  v_dot2_f32_bf16 v128, v161, v216, v128
  v_dot2_f32_bf16 v132, v161, v161, v132
  v_dot2_f32_bf16 v128, v162, v216, v128
  v_dot2_f32_bf16 v132, v162, v162, v132
  v_dot2_f32_bf16 v128, v163, v216, v128
  v_dot2_f32_bf16 v132, v163, v163, v132
  s_waitcnt vmcnt(4)
  v_dot2_f32_bf16 v152, v44, s57, v144
  v_dot2_f32_bf16 v153, v44, s58, v145
  v_dot2_f32_bf16 v154, v45, s57, v146
  v_dot2_f32_bf16 v155, v45, s58, v147
  v_dot2_f32_bf16 v156, v46, s57, v148
  v_dot2_f32_bf16 v157, v46, s58, v149
  v_dot2_f32_bf16 v158, v47, s57, v150
  v_dot2_f32_bf16 v159, v47, s58, v151
  buffer_load_dwordx4 v[24:27], v3, s[24:27], s41 offen offset:768 nt
  v_cvt_pk_bf16_f32 v164, v152, v153
  v_cvt_pk_bf16_f32 v165, v154, v155
  v_cvt_pk_bf16_f32 v166, v156, v157
  v_cvt_pk_bf16_f32 v167, v158, v159
  ds_write_b128 v5, v[164:167] offset:768
  v_add_f32_dpp v136, v128, v128 row_ror:8 row_mask:0xf bank_mask:0x3
  v_dot2_f32_bf16 v129, v164, v216, 0
  v_dot2_f32_bf16 v133, v164, v164, 0
  v_dot2_f32_bf16 v129, v165, v216, v129
  v_dot2_f32_bf16 v133, v165, v165, v133
  v_dot2_f32_bf16 v129, v166, v216, v129
  v_dot2_f32_bf16 v133, v166, v166, v133
  v_dot2_f32_bf16 v129, v167, v216, v129
  v_dot2_f32_bf16 v133, v167, v167, v133
  v_add_f32_dpp v136, v132, v132 row_ror:8 row_mask:0xf bank_mask:0xc
  s_waitcnt vmcnt(4)
  v_dot2_f32_bf16 v152, v48, s57, v144
  v_dot2_f32_bf16 v153, v48, s58, v145
  v_dot2_f32_bf16 v154, v49, s57, v146
  v_dot2_f32_bf16 v155, v49, s58, v147
  v_dot2_f32_bf16 v156, v50, s57, v148
  v_dot2_f32_bf16 v157, v50, s58, v149
  v_dot2_f32_bf16 v158, v51, s57, v150
  v_dot2_f32_bf16 v159, v51, s58, v151
  buffer_load_dwordx4 v[28:31], v3, s[24:27], s42 offen nt
  v_cvt_pk_bf16_f32 v160, v152, v153
  v_cvt_pk_bf16_f32 v161, v154, v155
  v_cvt_pk_bf16_f32 v162, v156, v157
  v_cvt_pk_bf16_f32 v163, v158, v159
  ds_write_b128 v253, v[160:163] offset:1536
  v_add_f32_dpp v137, v129, v129 row_ror:8 row_mask:0xf bank_mask:0x3
  v_dot2_f32_bf16 v130, v160, v216, 0
  v_dot2_f32_bf16 v134, v160, v160, 0
  v_dot2_f32_bf16 v130, v161, v216, v130
  v_dot2_f32_bf16 v134, v161, v161, v134
  v_dot2_f32_bf16 v130, v162, v216, v130
  v_dot2_f32_bf16 v134, v162, v162, v134
  v_dot2_f32_bf16 v130, v163, v216, v130
  v_dot2_f32_bf16 v134, v163, v163, v134
  v_add_f32_dpp v137, v133, v133 row_ror:8 row_mask:0xf bank_mask:0xc
  s_waitcnt vmcnt(4)
  v_dot2_f32_bf16 v152, v52, s57, v144
  v_dot2_f32_bf16 v153, v52, s58, v145
  v_dot2_f32_bf16 v154, v53, s57, v146
  v_dot2_f32_bf16 v155, v53, s58, v147
  v_dot2_f32_bf16 v156, v54, s57, v148
  v_dot2_f32_bf16 v157, v54, s58, v149
  v_dot2_f32_bf16 v158, v55, s57, v150
  v_dot2_f32_bf16 v159, v55, s58, v151
  buffer_load_dwordx4 v[32:35], v3, s[24:27], s42 offen offset:768 nt
  v_cvt_pk_bf16_f32 v164, v152, v153
  v_cvt_pk_bf16_f32 v165, v154, v155
  v_cvt_pk_bf16_f32 v166, v156, v157
  v_cvt_pk_bf16_f32 v167, v158, v159
  ds_write_b128 v254, v[164:167] offset:2304
  v_add_f32_dpp v138, v130, v130 row_ror:8 row_mask:0xf bank_mask:0x3
  v_dot2_f32_bf16 v131, v164, v216, 0
  v_dot2_f32_bf16 v135, v164, v164, 0
  v_dot2_f32_bf16 v131, v165, v216, v131
  v_dot2_f32_bf16 v135, v165, v165, v135
  v_dot2_f32_bf16 v131, v166, v216, v131
  v_dot2_f32_bf16 v135, v166, v166, v135
  v_dot2_f32_bf16 v131, v167, v216, v131
  v_dot2_f32_bf16 v135, v167, v167, v135
  v_add_f32_dpp v138, v134, v134 row_ror:8 row_mask:0xf bank_mask:0xc
  s_mov_b32 s62, 24576
  s_cmp_eq_u32 s66, 5
  s_cselect_b32 s62, 0xfffe2000, s62
  v_add_f32_dpp v140, v136, v136 row_half_mirror row_mask:0xf bank_mask:0x5
  v_add_f32_dpp v139, v131, v131 row_ror:8 row_mask:0xf bank_mask:0x3
  v_add_u32 v4, s62, v4
  v_add_f32_dpp v140, v137, v137 row_half_mirror row_mask:0xf bank_mask:0xa
  v_add_f32_dpp v139, v135, v135 row_ror:8 row_mask:0xf bank_mask:0xc
  v_add_f32_dpp v141, v138, v138 row_half_mirror row_mask:0xf bank_mask:0x5
  v_add_u32 v5, s62, v5
  v_add_f32_dpp v140, v140, v140 quad_perm:[1,0,3,2] row_mask:0xf bank_mask:0xf
  v_add_f32_dpp v141, v139, v139 row_half_mirror row_mask:0xf bank_mask:0xa
  v_add_u32 v253, s62, v253
  v_add_f32_dpp v140, v140, v140 quad_perm:[2,3,0,1] row_mask:0xf bank_mask:0xf
  v_add_f32_dpp v141, v141, v141 quad_perm:[1,0,3,2] row_mask:0xf bank_mask:0xf
  v_add_u32 v254, s62, v254
  s_mov_b32 s63, 768
  s_cmp_eq_u32 s66, 5
  s_cselect_b32 s62, 0xfffff100, s63
  v_add_f32_dpp v141, v141, v141 quad_perm:[2,3,0,1] row_mask:0xf bank_mask:0xf
  s_cbranch_scc1 L_keepst_24
  s_mov_b64 exec, s[50:51]
  ds_write_b32 v255, v140
  ds_write_b32 v255, v141 offset:8
  s_mov_b64 exec, -1
L_keepst_24:
  s_add_u32 s66, s66, 1
  v_add_u32 v255, s62, v255
  s_setpc_b64 s[68:69]
L_helper:
  v_lshlrev_b32 v1, 4, v0
  v_and_b32 v2, 15, v0
  v_lshrrev_b32 v3, 4, v0
  v_mov_b32 v14, 0
  v_lshlrev_b32 v4, 1, v3
  v_xor_b32 v4, v2, v4
  v_mul_u32_u24 v5, 768, v3
  v_lshl_add_u32 v12, v4, 4, v5
  v_xor_b32 v4, 8, v4
  v_lshl_add_u32 v13, v4, 4, v5
  v_lshrrev_b32 v4, 1, v0
  v_mul_u32_u24 v4, 768, v4
  v_and_b32 v5, 1, v0
  v_lshl_add_u32 v4, v5, 4, v4
  s_lshl_b32 s61, s56, 5
  v_add_u32 v11, s61, v4
  s_lshr_b32 s60, s56, 1
  s_lshl_b32 s60, s60, 10
  s_and_b32 s61, s56, 1
  s_lshl_b32 s61, s61, 9
  s_add_u32 s60, s60, s61
  v_lshrrev_b32 v4, 1, v3
  v_lshlrev_b32 v4, 8, v4
  v_lshl_add_u32 v4, v2, 4, v4
  v_and_b32 v5, 1, v3
  v_lshl_add_u32 v4, v5, 3, v4
  v_add_u32 v8, s60, v4
  s_waitcnt lgkmcnt(0)
  s_mov_b32 s32, s22
  s_mov_b32 s33, s23
  s_mov_b32 s34, 268435456
  s_mov_b32 s35, 0x20000
  s_cmp_eq_u32 s3, 1
  s_cbranch_scc1 L_h1a
  s_cmp_eq_u32 s3, 0
  s_cbranch_scc1 L_h0a
  s_branch L_hb1
L_h1a:
  s_mov_b32 s28, s10
  s_mov_b32 s29, s11
  s_mov_b32 s30, 294912
  s_mov_b32 s31, 0x20000
  s_mov_b32 m0, 24576
  s_mov_b32 s62, 0
  buffer_load_dwordx4 v11, s[28:31], s62 offen lds
  s_mov_b32 m0, 25600
  s_mov_b32 s62, 24576
  buffer_load_dwordx4 v11, s[28:31], s62 offen lds
  s_mov_b32 m0, 26624
  s_mov_b32 s62, 49152
  buffer_load_dwordx4 v11, s[28:31], s62 offen lds
  s_mov_b32 m0, 27648
  s_mov_b32 s62, 73728
  buffer_load_dwordx4 v11, s[28:31], s62 offen lds
  s_mov_b32 m0, 28672
  s_mov_b32 s62, 98304
  buffer_load_dwordx4 v11, s[28:31], s62 offen lds
  s_mov_b32 m0, 29696
  s_mov_b32 s62, 122880
  buffer_load_dwordx4 v11, s[28:31], s62 offen lds
  s_mov_b32 m0, 30720
  s_mov_b32 s62, 147456
  buffer_load_dwordx4 v11, s[28:31], s62 offen lds
  s_mov_b32 m0, 31744
  s_mov_b32 s62, 172032
  buffer_load_dwordx4 v11, s[28:31], s62 offen lds
  s_mov_b32 m0, 32768
  s_mov_b32 s62, 196608
  buffer_load_dwordx4 v11, s[28:31], s62 offen lds
  s_mov_b32 m0, 33792
  s_mov_b32 s62, 221184
  buffer_load_dwordx4 v11, s[28:31], s62 offen lds
  s_mov_b32 m0, 34816
  s_mov_b32 s62, 245760
  buffer_load_dwordx4 v11, s[28:31], s62 offen lds
  s_mov_b32 m0, 35840
  s_mov_b32 s62, 270336
  buffer_load_dwordx4 v11, s[28:31], s62 offen lds
  buffer_load_dword v9, v14, s[32:35], 0 offen offset:0 sc1
  v_mov_b32 v4, -1
  v_mov_b32 v5, -1
  v_mov_b32 v6, -1
  v_mov_b32 v7, -1
  s_lshl_b32 s60, s56, 9
  s_add_u32 s62, s60, 4096
  s_add_u32 s63, s60, 20480
  s_add_u32 s61, s60, 36864
  s_mov_b32 s64, -1
  s_mov_b32 s65, 0
  s_mov_b64 exec, s[64:65]
  buffer_store_dwordx4 v[4:7], v1, s[32:35], s62 offen sc1
  buffer_store_dwordx4 v[4:7], v1, s[32:35], s63 offen sc1
  buffer_store_dwordx4 v[4:7], v1, s[32:35], s61 offen sc1
  s_add_u32 s62, s60, 65536
  buffer_store_dwordx4 v[4:7], v1, s[32:35], s62 offen sc1
  s_mov_b64 exec, -1
  s_waitcnt vmcnt(5)
  s_branch L_hb1
L_h0a:
  s_mov_b32 s24, s4
  s_mov_b32 s25, s5
  s_mov_b32 s26, 12288
  s_mov_b32 s27, 0x20000
  s_mov_b32 s60, 0
  s_mov_b32 m0, 0
  s_add_u32 s62, s60, 0
  buffer_load_dwordx4 v12, s[24:27], s62 offen lds
  s_mov_b32 m0, 1024
  s_add_u32 s62, s60, 3072
  buffer_load_dwordx4 v13, s[24:27], s62 offen lds
  s_mov_b32 m0, 2048
  s_add_u32 s62, s60, 6144
  buffer_load_dwordx4 v12, s[24:27], s62 offen lds
  s_mov_b32 m0, 3072
  s_add_u32 s62, s60, 9216
  buffer_load_dwordx4 v13, s[24:27], s62 offen lds
  s_mov_b32 m0, 4096
  s_add_u32 s62, s60, 256
  buffer_load_dwordx4 v12, s[24:27], s62 offen lds
  s_mov_b32 m0, 5120
  s_add_u32 s62, s60, 3328
  buffer_load_dwordx4 v13, s[24:27], s62 offen lds
  s_mov_b32 m0, 6144
  s_add_u32 s62, s60, 6400
  buffer_load_dwordx4 v12, s[24:27], s62 offen lds
  s_mov_b32 m0, 7168
  s_add_u32 s62, s60, 9472
  buffer_load_dwordx4 v13, s[24:27], s62 offen lds
  s_mov_b32 m0, 8192
  s_add_u32 s62, s60, 512
  buffer_load_dwordx4 v12, s[24:27], s62 offen lds
  s_mov_b32 m0, 9216
  s_add_u32 s62, s60, 3584
  buffer_load_dwordx4 v13, s[24:27], s62 offen lds
  s_mov_b32 m0, 10240
  s_add_u32 s62, s60, 6656
  buffer_load_dwordx4 v12, s[24:27], s62 offen lds
  s_mov_b32 m0, 11264
  s_add_u32 s62, s60, 9728
  buffer_load_dwordx4 v13, s[24:27], s62 offen lds
  buffer_load_dword v15, v14, s[32:35], 0 offen offset:0 sc1
  s_waitcnt vmcnt(0)
  s_branch L_hb1
L_hb1:
  s_mov_b32 s24, s4
  s_mov_b32 s25, s5
  s_mov_b32 s26, 12288
  s_mov_b32 s27, 0x20000
  s_mov_b32 s44, s14
  s_mov_b32 s45, s15
  s_mov_b32 s46, 294912
  s_mov_b32 s47, 0x20000
  s_mov_b32 s52, s18
  s_mov_b32 s53, s19
  s_mov_b32 s54, 12288
  s_mov_b32 s55, 0x20000
  v_and_b32 v228, 7, v2
  v_lshlrev_b32 v228, 1, v228
  v_lshlrev_b32 v229, 8, v2
  v_add_u32 v230, 0, v3
  v_xor_b32 v230, v230, v228
  v_lshl_add_u32 v16, v230, 4, v229
  v_add_u32 v230, 4, v3
  v_xor_b32 v230, v230, v228
  v_lshl_add_u32 v17, v230, 4, v229
  v_add_u32 v230, 8, v3
  v_xor_b32 v230, v230, v228
  v_lshl_add_u32 v18, v230, 4, v229
  v_add_u32 v230, 12, v3
  v_xor_b32 v230, v230, v228
  v_lshl_add_u32 v19, v230, 4, v229
  v_lshrrev_b32 v228, 2, v2
  v_lshl_add_u32 v228, v3, 3, v228
  v_lshlrev_b32 v228, 5, v228
  v_and_b32 v229, 3, v2
  v_lshl_add_u32 v10, v229, 3, v228
  v_mov_b32 v224, 0x3f803f80
  v_mov_b32 v225, 0x3f803f80
  v_mov_b32 v226, 0x3f803f80
  v_mov_b32 v227, 0x3f803f80
  s_barrier
  s_cmp_eq_u32 s3, 0
  s_cbranch_scc1 L_h0b
  s_cmp_eq_u32 s3, 1
  s_cbranch_scc0 L_notw1_25
  s_waitcnt vmcnt(0)
  v_add_u32 v9, 1, v9
  s_lshl_b32 s62, s56, 7
  s_add_u32 s62, s62, 49152
  s_mov_b64 exec, 1
  buffer_store_dword v9, v14, s[32:35], s62 offen sc1
  s_mov_b64 exec, -1
  s_branch L_hb1c
L_notw1_25:
  s_cmp_eq_u32 s3, 3
  s_cbranch_scc1 L_h3b
  s_cmp_eq_u32 s3, 2
  s_cbranch_scc0 L_hb1c
  s_mov_b32 s40, s12
  s_mov_b32 s41, s13
  s_mov_b32 s42, 294912
  s_mov_b32 s43, 0x20000
  s_mul_i32 s60, s56, 12288
  s_mov_b32 m0, 12288
  s_add_u32 s62, s60, 0
  buffer_load_dwordx4 v12, s[40:43], s62 offen lds
  s_mov_b32 m0, 13312
  s_add_u32 s62, s60, 3072
  buffer_load_dwordx4 v13, s[40:43], s62 offen lds
  s_mov_b32 m0, 14336
  s_add_u32 s62, s60, 6144
  buffer_load_dwordx4 v12, s[40:43], s62 offen lds
  s_mov_b32 m0, 15360
  s_add_u32 s62, s60, 9216
  buffer_load_dwordx4 v13, s[40:43], s62 offen lds
  s_mov_b32 m0, 16384
  s_add_u32 s62, s60, 256
  buffer_load_dwordx4 v12, s[40:43], s62 offen lds
  s_mov_b32 m0, 17408
  s_add_u32 s62, s60, 3328
  buffer_load_dwordx4 v13, s[40:43], s62 offen lds
  s_mov_b32 m0, 18432
  s_add_u32 s62, s60, 6400
  buffer_load_dwordx4 v12, s[40:43], s62 offen lds
  s_mov_b32 m0, 19456
  s_add_u32 s62, s60, 9472
  buffer_load_dwordx4 v13, s[40:43], s62 offen lds
  s_mov_b32 m0, 20480
  s_add_u32 s62, s60, 512
  buffer_load_dwordx4 v12, s[40:43], s62 offen lds
  s_mov_b32 m0, 21504
  s_add_u32 s62, s60, 3584
  buffer_load_dwordx4 v13, s[40:43], s62 offen lds
  s_mov_b32 m0, 22528
  s_add_u32 s62, s60, 6656
  buffer_load_dwordx4 v12, s[40:43], s62 offen lds
  s_mov_b32 m0, 23552
  s_add_u32 s62, s60, 9728
  buffer_load_dwordx4 v13, s[40:43], s62 offen lds
  s_branch L_hb1c
L_h3b:
  ds_read_b128 v[20:23], v16 offset:0
  ds_read_b128 v[24:27], v17 offset:0
  ds_read_b128 v[28:31], v18 offset:0
  ds_read_b128 v[32:35], v19 offset:0
  ds_read_b128 v[36:39], v16 offset:4096
  ds_read_b128 v[40:43], v17 offset:4096
  ds_read_b128 v[44:47], v18 offset:4096
  ds_read_b128 v[48:51], v19 offset:4096
  ds_read_b128 v[52:55], v16 offset:8192
  ds_read_b128 v[56:59], v17 offset:8192
  ds_read_b128 v[60:63], v18 offset:8192
  ds_read_b128 v[64:67], v19 offset:8192
  s_waitcnt lgkmcnt(11)
  v_dot2_f32_bf16 v220, v20, v20, 0
  v_dot2_f32_bf16 v216, v20, v224, 0
  v_dot2_f32_bf16 v221, v21, v21, 0
  v_dot2_f32_bf16 v217, v21, v224, 0
  v_dot2_f32_bf16 v222, v22, v22, 0
  v_dot2_f32_bf16 v218, v22, v224, 0
  v_dot2_f32_bf16 v223, v23, v23, 0
  v_dot2_f32_bf16 v219, v23, v224, 0
  s_waitcnt lgkmcnt(10)
  v_dot2_f32_bf16 v220, v24, v24, v220
  v_dot2_f32_bf16 v216, v24, v224, v216
  v_dot2_f32_bf16 v221, v25, v25, v221
  v_dot2_f32_bf16 v217, v25, v224, v217
  v_dot2_f32_bf16 v222, v26, v26, v222
  v_dot2_f32_bf16 v218, v26, v224, v218
  v_dot2_f32_bf16 v223, v27, v27, v223
  v_dot2_f32_bf16 v219, v27, v224, v219
  s_waitcnt lgkmcnt(9)
  v_dot2_f32_bf16 v220, v28, v28, v220
  v_dot2_f32_bf16 v216, v28, v224, v216
  v_dot2_f32_bf16 v221, v29, v29, v221
  v_dot2_f32_bf16 v217, v29, v224, v217
  v_dot2_f32_bf16 v222, v30, v30, v222
  v_dot2_f32_bf16 v218, v30, v224, v218
  v_dot2_f32_bf16 v223, v31, v31, v223
  v_dot2_f32_bf16 v219, v31, v224, v219
  s_waitcnt lgkmcnt(8)
  v_dot2_f32_bf16 v220, v32, v32, v220
  v_dot2_f32_bf16 v216, v32, v224, v216
  v_dot2_f32_bf16 v221, v33, v33, v221
  v_dot2_f32_bf16 v217, v33, v224, v217
  v_dot2_f32_bf16 v222, v34, v34, v222
  v_dot2_f32_bf16 v218, v34, v224, v218
  v_dot2_f32_bf16 v223, v35, v35, v223
  v_dot2_f32_bf16 v219, v35, v224, v219
  s_waitcnt lgkmcnt(7)
  v_dot2_f32_bf16 v220, v36, v36, v220
  v_dot2_f32_bf16 v216, v36, v224, v216
  v_dot2_f32_bf16 v221, v37, v37, v221
  v_dot2_f32_bf16 v217, v37, v224, v217
  v_dot2_f32_bf16 v222, v38, v38, v222
  v_dot2_f32_bf16 v218, v38, v224, v218
  v_dot2_f32_bf16 v223, v39, v39, v223
  v_dot2_f32_bf16 v219, v39, v224, v219
  s_waitcnt lgkmcnt(6)
  v_dot2_f32_bf16 v220, v40, v40, v220
  v_dot2_f32_bf16 v216, v40, v224, v216
  v_dot2_f32_bf16 v221, v41, v41, v221
  v_dot2_f32_bf16 v217, v41, v224, v217
  v_dot2_f32_bf16 v222, v42, v42, v222
  v_dot2_f32_bf16 v218, v42, v224, v218
  v_dot2_f32_bf16 v223, v43, v43, v223
  v_dot2_f32_bf16 v219, v43, v224, v219
  s_waitcnt lgkmcnt(5)
  v_dot2_f32_bf16 v220, v44, v44, v220
  v_dot2_f32_bf16 v216, v44, v224, v216
  v_dot2_f32_bf16 v221, v45, v45, v221
  v_dot2_f32_bf16 v217, v45, v224, v217
  v_dot2_f32_bf16 v222, v46, v46, v222
  v_dot2_f32_bf16 v218, v46, v224, v218
  v_dot2_f32_bf16 v223, v47, v47, v223
  v_dot2_f32_bf16 v219, v47, v224, v219
  s_waitcnt lgkmcnt(4)
  v_dot2_f32_bf16 v220, v48, v48, v220
  v_dot2_f32_bf16 v216, v48, v224, v216
  v_dot2_f32_bf16 v221, v49, v49, v221
  v_dot2_f32_bf16 v217, v49, v224, v217
  v_dot2_f32_bf16 v222, v50, v50, v222
  v_dot2_f32_bf16 v218, v50, v224, v218
  v_dot2_f32_bf16 v223, v51, v51, v223
  v_dot2_f32_bf16 v219, v51, v224, v219
  s_waitcnt lgkmcnt(3)
  v_dot2_f32_bf16 v220, v52, v52, v220
  v_dot2_f32_bf16 v216, v52, v224, v216
  v_dot2_f32_bf16 v221, v53, v53, v221
  v_dot2_f32_bf16 v217, v53, v224, v217
  v_dot2_f32_bf16 v222, v54, v54, v222
  v_dot2_f32_bf16 v218, v54, v224, v218
  v_dot2_f32_bf16 v223, v55, v55, v223
  v_dot2_f32_bf16 v219, v55, v224, v219
  s_waitcnt lgkmcnt(2)
  v_dot2_f32_bf16 v220, v56, v56, v220
  v_dot2_f32_bf16 v216, v56, v224, v216
  v_dot2_f32_bf16 v221, v57, v57, v221
  v_dot2_f32_bf16 v217, v57, v224, v217
  v_dot2_f32_bf16 v222, v58, v58, v222
  v_dot2_f32_bf16 v218, v58, v224, v218
  v_dot2_f32_bf16 v223, v59, v59, v223
  v_dot2_f32_bf16 v219, v59, v224, v219
  s_waitcnt lgkmcnt(1)
  v_dot2_f32_bf16 v220, v60, v60, v220
  v_dot2_f32_bf16 v216, v60, v224, v216
  v_dot2_f32_bf16 v221, v61, v61, v221
  v_dot2_f32_bf16 v217, v61, v224, v217
  v_dot2_f32_bf16 v222, v62, v62, v222
  v_dot2_f32_bf16 v218, v62, v224, v218
  v_dot2_f32_bf16 v223, v63, v63, v223
  v_dot2_f32_bf16 v219, v63, v224, v219
  s_waitcnt lgkmcnt(0)
  v_dot2_f32_bf16 v220, v64, v64, v220
  v_dot2_f32_bf16 v216, v64, v224, v216
  v_dot2_f32_bf16 v221, v65, v65, v221
  v_dot2_f32_bf16 v217, v65, v224, v217
  v_dot2_f32_bf16 v222, v66, v66, v222
  v_dot2_f32_bf16 v218, v66, v224, v218
  v_dot2_f32_bf16 v223, v67, v67, v223
  v_dot2_f32_bf16 v219, v67, v224, v219
  s_nop 1
  v_pk_add_f32 v[220:221], v[220:221], v[222:223]
  v_pk_add_f32 v[216:217], v[216:217], v[218:219]
  v_add_f32 v220, v220, v221
  v_add_f32 v221, v216, v217
  s_nop 1
  v_permlane16_swap_b32 v220, v221
  v_add_f32 v220, v220, v221
  v_mov_b32 v221, v220
  s_nop 1
  v_permlane32_swap_b32 v221, v220
  v_add_f32 v220, v220, v221
  v_mul_f32 v220, 0x3b2aaaab, v220
  v_mov_b32 v221, v220
  v_mov_b32 v222, v220
  s_nop 1
  v_permlane16_swap_b32 v221, v222
  v_fma_f32 v223, -v222, v222, v221
  v_max_f32 v223, 0, v223
  v_add_f32 v223, 0x3727c5ac, v223
  v_rsq_f32 v223, v223
  v_lshlrev_b32 v4, 3, v2
  v_add_u32 v4, 61952, v4
  ds_write_b64 v4, v[222:223]
  s_waitcnt lgkmcnt(0)
L_hb1c:
  s_barrier
  s_branch L_hb2
L_h0b:
  v_add_u32 v15, 1, v15
  v_min_u32 v7, 23, v0
  v_lshlrev_b32 v7, 7, v7
  v_add_u32 v7, 49152, v7
  v_readfirstlane_b32 s70, v15
  buffer_load_dword v9, v7, s[32:35], 0 offen sc1
  ds_read_b128 v[20:23], v16 offset:0
  ds_read_b128 v[24:27], v17 offset:0
  ds_read_b128 v[28:31], v18 offset:0
  ds_read_b128 v[32:35], v19 offset:0
  ds_read_b128 v[36:39], v16 offset:4096
  ds_read_b128 v[40:43], v17 offset:4096
  ds_read_b128 v[44:47], v18 offset:4096
  ds_read_b128 v[48:51], v19 offset:4096
  ds_read_b128 v[52:55], v16 offset:8192
  ds_read_b128 v[56:59], v17 offset:8192
  ds_read_b128 v[60:63], v18 offset:8192
  ds_read_b128 v[64:67], v19 offset:8192
  s_waitcnt lgkmcnt(3)
  ds_read_b64_tr_b16 v[160:161], v10 offset:24576
  ds_read_b64_tr_b16 v[162:163], v10 offset:24704
  ds_read_b64_tr_b16 v[164:165], v10 offset:25600
  ds_read_b64_tr_b16 v[166:167], v10 offset:25728
  ds_read_b64_tr_b16 v[168:169], v10 offset:26624
  ds_read_b64_tr_b16 v[170:171], v10 offset:26752
  ds_read_b64_tr_b16 v[172:173], v10 offset:27648
  ds_read_b64_tr_b16 v[174:175], v10 offset:27776
  ds_read_b64_tr_b16 v[176:177], v10 offset:28672
  ds_read_b64_tr_b16 v[178:179], v10 offset:28800
  ds_read_b64_tr_b16 v[180:181], v10 offset:29696
  ds_read_b64_tr_b16 v[182:183], v10 offset:29824
  s_waitcnt lgkmcnt(10)
  ds_read_b64_tr_b16 v[184:185], v10 offset:30720
  ds_read_b64_tr_b16 v[186:187], v10 offset:30848
  v_mfma_f32_16x16x32_bf16 v[208:211], v[160:163], v[20:23], 0
  v_mfma_f32_16x16x32_bf16 v[212:215], v[160:163], v[224:227], 0
  s_waitcnt lgkmcnt(10)
  ds_read_b64_tr_b16 v[188:189], v10 offset:31744
  ds_read_b64_tr_b16 v[190:191], v10 offset:31872
  v_mfma_f32_16x16x32_bf16 v[208:211], v[164:167], v[24:27], v[208:211]
  v_mfma_f32_16x16x32_bf16 v[212:215], v[164:167], v[224:227], v[212:215]
  s_waitcnt lgkmcnt(10)
  ds_read_b64_tr_b16 v[192:193], v10 offset:32768
  ds_read_b64_tr_b16 v[194:195], v10 offset:32896
  v_mfma_f32_16x16x32_bf16 v[208:211], v[168:171], v[28:31], v[208:211]
  v_mfma_f32_16x16x32_bf16 v[212:215], v[168:171], v[224:227], v[212:215]
  s_waitcnt lgkmcnt(10)
  ds_read_b64_tr_b16 v[196:197], v10 offset:33792
  ds_read_b64_tr_b16 v[198:199], v10 offset:33920
  v_mfma_f32_16x16x32_bf16 v[208:211], v[172:175], v[32:35], v[208:211]
  v_mfma_f32_16x16x32_bf16 v[212:215], v[172:175], v[224:227], v[212:215]
  s_waitcnt lgkmcnt(10)
  ds_read_b64_tr_b16 v[200:201], v10 offset:34816
  ds_read_b64_tr_b16 v[202:203], v10 offset:34944
  v_mfma_f32_16x16x32_bf16 v[208:211], v[176:179], v[36:39], v[208:211]
  v_mfma_f32_16x16x32_bf16 v[212:215], v[176:179], v[224:227], v[212:215]
  s_waitcnt lgkmcnt(10)
  ds_read_b64_tr_b16 v[204:205], v10 offset:35840
  ds_read_b64_tr_b16 v[206:207], v10 offset:35968
  v_mfma_f32_16x16x32_bf16 v[208:211], v[180:183], v[40:43], v[208:211]
  v_mfma_f32_16x16x32_bf16 v[212:215], v[180:183], v[224:227], v[212:215]
  s_waitcnt lgkmcnt(10)
  v_mfma_f32_16x16x32_bf16 v[208:211], v[184:187], v[44:47], v[208:211]
  v_mfma_f32_16x16x32_bf16 v[212:215], v[184:187], v[224:227], v[212:215]
  s_waitcnt lgkmcnt(8)
  v_mfma_f32_16x16x32_bf16 v[208:211], v[188:191], v[48:51], v[208:211]
  v_mfma_f32_16x16x32_bf16 v[212:215], v[188:191], v[224:227], v[212:215]
  s_waitcnt lgkmcnt(6)
  v_mfma_f32_16x16x32_bf16 v[208:211], v[192:195], v[52:55], v[208:211]
  v_mfma_f32_16x16x32_bf16 v[212:215], v[192:195], v[224:227], v[212:215]
  s_waitcnt lgkmcnt(4)
  v_mfma_f32_16x16x32_bf16 v[208:211], v[196:199], v[56:59], v[208:211]
  v_mfma_f32_16x16x32_bf16 v[212:215], v[196:199], v[224:227], v[212:215]
  s_waitcnt lgkmcnt(2)
  v_mfma_f32_16x16x32_bf16 v[208:211], v[200:203], v[60:63], v[208:211]
  v_mfma_f32_16x16x32_bf16 v[212:215], v[200:203], v[224:227], v[212:215]
  s_waitcnt lgkmcnt(0)
  v_mfma_f32_16x16x32_bf16 v[208:211], v[204:207], v[64:67], v[208:211]
  v_mfma_f32_16x16x32_bf16 v[212:215], v[204:207], v[224:227], v[212:215]
  s_barrier
  v_lshlrev_b32 v4, 3, v2
  v_add_u32 v4, 61952, v4
  ds_read_b64 v[220:221], v4
  s_waitcnt lgkmcnt(0)
  s_nop 2
  v_fma_f32 v208, -v220, v212, v208
  v_fma_f32 v209, -v220, v213, v209
  v_fma_f32 v210, -v220, v214, v210
  v_fma_f32 v211, -v220, v215, v211
  v_mul_f32 v208, v221, v208
  v_mul_f32 v209, v221, v209
  v_mul_f32 v210, v221, v210
  v_mul_f32 v211, v221, v211
  v_cvt_pk_bf16_f32 v212, v208, v209
  v_cvt_pk_bf16_f32 v213, v210, v211
  v_min_u32 v212, -2, v212
  v_min_u32 v213, -2, v213
  s_mov_b32 s62, 4096
  s_mov_b32 s63, 65536
  buffer_store_dwordx2 v[212:213], v8, s[32:35], s63 offen
  buffer_store_dwordx2 v[212:213], v8, s[32:35], s62 offen sc1
  s_waitcnt vmcnt(2)
  v_cmp_ne_u32 vcc, s70, v9
  s_cbranch_vccz L_haveflags_26
  s_mov_b32 s71, 0
L_flg_27:
  buffer_load_dword v9, v7, s[32:35], 0 offen sc1
  s_add_u32 s71, s71, 1
  s_cmp_gt_u32 s71, 200000
  s_cbranch_scc1 L_flgd_29
L_flgc_28:
  s_waitcnt vmcnt(0)
  v_cmp_ne_u32 vcc, s70, v9
  s_cbranch_vccnz L_flg_27
L_flgd_29:
  s_waitcnt vmcnt(0)
L_haveflags_26:
  s_mov_b32 s62, 4096
  s_mov_b32 s71, 0
L_q2_30:
  s_mov_b32 s62, 65536
  s_mov_b32 s63, 69632
  s_mov_b32 s64, 73728
  buffer_load_dwordx4 v[68:71], v1, s[32:35], s62 offen offset:0 sc1
  buffer_load_dwordx4 v[72:75], v1, s[32:35], s62 offen offset:1024 sc1
  buffer_load_dwordx4 v[76:79], v1, s[32:35], s62 offen offset:2048 sc1
  buffer_load_dwordx4 v[80:83], v1, s[32:35], s62 offen offset:3072 sc1
  buffer_load_dwordx4 v[84:87], v1, s[32:35], s63 offen offset:0 sc1
  buffer_load_dwordx4 v[88:91], v1, s[32:35], s63 offen offset:1024 sc1
  buffer_load_dwordx4 v[92:95], v1, s[32:35], s63 offen offset:2048 sc1
  buffer_load_dwordx4 v[96:99], v1, s[32:35], s63 offen offset:3072 sc1
  buffer_load_dwordx4 v[100:103], v1, s[32:35], s64 offen offset:0 sc1
  buffer_load_dwordx4 v[104:107], v1, s[32:35], s64 offen offset:1024 sc1
  buffer_load_dwordx4 v[108:111], v1, s[32:35], s64 offen offset:2048 sc1
  buffer_load_dwordx4 v[112:115], v1, s[32:35], s64 offen offset:3072 sc1
  s_add_u32 s71, s71, 1
  s_cmp_gt_u32 s71, 200000
  s_cbranch_scc1 L_q2d_32
  s_waitcnt vmcnt(0)
  v_max3_u32 v4, v68, v69, v70
  v_max3_u32 v5, v92, v93, v94
  v_max3_u32 v4, v4, v71, v72
  v_max3_u32 v5, v5, v95, v96
  v_max3_u32 v4, v4, v73, v74
  v_max3_u32 v5, v5, v97, v98
  v_max3_u32 v4, v4, v75, v76
  v_max3_u32 v5, v5, v99, v100
  v_max3_u32 v4, v4, v77, v78
  v_max3_u32 v5, v5, v101, v102
  v_max3_u32 v4, v4, v79, v80
  v_max3_u32 v5, v5, v103, v104
  v_max3_u32 v4, v4, v81, v82
  v_max3_u32 v5, v5, v105, v106
  v_max3_u32 v4, v4, v83, v84
  v_max3_u32 v5, v5, v107, v108
  v_max3_u32 v4, v4, v85, v86
  v_max3_u32 v5, v5, v109, v110
  v_max3_u32 v4, v4, v87, v88
  v_max3_u32 v5, v5, v111, v112
  v_max3_u32 v4, v4, v89, v90
  v_max3_u32 v5, v5, v113, v114
  v_max_u32 v4, v4, v91
  v_max_u32 v5, v5, v115
  v_max_u32 v4, v4, v5
  v_cmp_eq_u32 vcc, -1, v4
  s_cbranch_vccnz L_q2a_31
  s_branch L_q2d_32
L_q2a_31:
  s_cmp_lt_u32 s71, 4
  s_cbranch_scc1 L_q2_30
  s_mov_b32 s62, 4096
  s_mov_b32 s63, 8192
  s_mov_b32 s64, 12288
  buffer_load_dwordx4 v[68:71], v1, s[32:35], s62 offen offset:0 sc1
  buffer_load_dwordx4 v[72:75], v1, s[32:35], s62 offen offset:1024 sc1
  buffer_load_dwordx4 v[76:79], v1, s[32:35], s62 offen offset:2048 sc1
  buffer_load_dwordx4 v[80:83], v1, s[32:35], s62 offen offset:3072 sc1
  buffer_load_dwordx4 v[84:87], v1, s[32:35], s63 offen offset:0 sc1
  buffer_load_dwordx4 v[88:91], v1, s[32:35], s63 offen offset:1024 sc1
  buffer_load_dwordx4 v[92:95], v1, s[32:35], s63 offen offset:2048 sc1
  buffer_load_dwordx4 v[96:99], v1, s[32:35], s63 offen offset:3072 sc1
  buffer_load_dwordx4 v[100:103], v1, s[32:35], s64 offen offset:0 sc1
  buffer_load_dwordx4 v[104:107], v1, s[32:35], s64 offen offset:1024 sc1
  buffer_load_dwordx4 v[108:111], v1, s[32:35], s64 offen offset:2048 sc1
  buffer_load_dwordx4 v[112:115], v1, s[32:35], s64 offen offset:3072 sc1
  s_waitcnt vmcnt(0)
  v_max3_u32 v4, v68, v69, v70
  v_max3_u32 v5, v92, v93, v94
  v_max3_u32 v4, v4, v71, v72
  v_max3_u32 v5, v5, v95, v96
  v_max3_u32 v4, v4, v73, v74
  v_max3_u32 v5, v5, v97, v98
  v_max3_u32 v4, v4, v75, v76
  v_max3_u32 v5, v5, v99, v100
  v_max3_u32 v4, v4, v77, v78
  v_max3_u32 v5, v5, v101, v102
  v_max3_u32 v4, v4, v79, v80
  v_max3_u32 v5, v5, v103, v104
  v_max3_u32 v4, v4, v81, v82
  v_max3_u32 v5, v5, v105, v106
  v_max3_u32 v4, v4, v83, v84
  v_max3_u32 v5, v5, v107, v108
  v_max3_u32 v4, v4, v85, v86
  v_max3_u32 v5, v5, v109, v110
  v_max3_u32 v4, v4, v87, v88
  v_max3_u32 v5, v5, v111, v112
  v_max3_u32 v4, v4, v89, v90
  v_max3_u32 v5, v5, v113, v114
  v_max_u32 v4, v4, v91
  v_max_u32 v5, v5, v115
  v_max_u32 v4, v4, v5
  v_cmp_eq_u32 vcc, -1, v4
  s_cbranch_vccnz L_q2_30
L_q2d_32:
  s_waitcnt vmcnt(0)
  s_barrier
  ds_read_b128 v[116:119], v16 offset:12288
  ds_read_b128 v[120:123], v17 offset:12288
  ds_read_b128 v[124:127], v18 offset:12288
  ds_read_b128 v[128:131], v19 offset:12288
  ds_read_b128 v[132:135], v16 offset:16384
  ds_read_b128 v[136:139], v17 offset:16384
  ds_read_b128 v[140:143], v18 offset:16384
  ds_read_b128 v[144:147], v19 offset:16384
  ds_read_b128 v[148:151], v16 offset:20480
  ds_read_b128 v[152:155], v17 offset:20480
  ds_read_b128 v[156:159], v18 offset:20480
  ds_read_b128 v[160:163], v19 offset:20480
  s_waitcnt lgkmcnt(11)
  v_mfma_f32_16x16x32_bf16 v[208:211], v[116:119], v[68:71], 0
  s_waitcnt lgkmcnt(10)
  v_mfma_f32_16x16x32_bf16 v[212:215], v[120:123], v[72:75], 0
  s_waitcnt lgkmcnt(9)
  v_mfma_f32_16x16x32_bf16 v[208:211], v[124:127], v[76:79], v[208:211]
  s_waitcnt lgkmcnt(8)
  v_mfma_f32_16x16x32_bf16 v[212:215], v[128:131], v[80:83], v[212:215]
  s_waitcnt lgkmcnt(7)
  v_mfma_f32_16x16x32_bf16 v[208:211], v[132:135], v[84:87], v[208:211]
  s_waitcnt lgkmcnt(6)
  v_mfma_f32_16x16x32_bf16 v[212:215], v[136:139], v[88:91], v[212:215]
  s_waitcnt lgkmcnt(5)
  v_mfma_f32_16x16x32_bf16 v[208:211], v[140:143], v[92:95], v[208:211]
  s_waitcnt lgkmcnt(4)
  v_mfma_f32_16x16x32_bf16 v[212:215], v[144:147], v[96:99], v[212:215]
  s_waitcnt lgkmcnt(3)
  v_mfma_f32_16x16x32_bf16 v[208:211], v[148:151], v[100:103], v[208:211]
  s_waitcnt lgkmcnt(2)
  v_mfma_f32_16x16x32_bf16 v[212:215], v[152:155], v[104:107], v[212:215]
  s_waitcnt lgkmcnt(1)
  v_mfma_f32_16x16x32_bf16 v[208:211], v[156:159], v[108:111], v[208:211]
  s_waitcnt lgkmcnt(0)
  v_mfma_f32_16x16x32_bf16 v[212:215], v[160:163], v[112:115], v[212:215]
  s_nop 7
  v_add_f32 v208, v208, v212
  v_add_f32 v209, v209, v213
  v_add_f32 v210, v210, v214
  v_add_f32 v211, v211, v215
  v_mul_f32 v208, 0x3d96c740, v208
  v_mul_f32 v209, 0x3d96c740, v209
  v_mul_f32 v210, 0x3d96c740, v210
  v_mul_f32 v211, 0x3d96c740, v211
  v_cvt_pk_bf16_f32 v212, v208, v209
  v_cvt_pk_bf16_f32 v213, v210, v211
  v_min_u32 v212, -2, v212
  v_min_u32 v213, -2, v213
  s_mov_b32 s62, 20480
  buffer_store_dwordx2 v[212:213], v8, s[32:35], s62 offen sc1
  s_branch L_hwvo
L_hb2:
  s_waitcnt vmcnt(0)
  s_barrier
L_hwvo:
  s_cmp_eq_u32 s3, 3
  s_cbranch_scc0 L_hwv2
  s_mov_b32 s48, s16
  s_mov_b32 s49, s17
  s_mov_b32 s50, 294912
  s_mov_b32 s51, 0x20000
  s_mov_b32 m0, 36864
  s_mov_b32 s62, 0
  buffer_load_dwordx4 v11, s[48:51], s62 offen lds
  s_mov_b32 m0, 37888
  s_mov_b32 s62, 24576
  buffer_load_dwordx4 v11, s[48:51], s62 offen lds
  s_mov_b32 m0, 38912
  s_mov_b32 s62, 49152
  buffer_load_dwordx4 v11, s[48:51], s62 offen lds
  s_mov_b32 m0, 39936
  s_mov_b32 s62, 73728
  buffer_load_dwordx4 v11, s[48:51], s62 offen lds
  s_mov_b32 m0, 40960
  s_mov_b32 s62, 98304
  buffer_load_dwordx4 v11, s[48:51], s62 offen lds
  s_mov_b32 m0, 41984
  s_mov_b32 s62, 122880
  buffer_load_dwordx4 v11, s[48:51], s62 offen lds
  s_mov_b32 m0, 43008
  s_mov_b32 s62, 147456
  buffer_load_dwordx4 v11, s[48:51], s62 offen lds
  s_mov_b32 m0, 44032
  s_mov_b32 s62, 172032
  buffer_load_dwordx4 v11, s[48:51], s62 offen lds
  s_mov_b32 m0, 45056
  s_mov_b32 s62, 196608
  buffer_load_dwordx4 v11, s[48:51], s62 offen lds
  s_mov_b32 m0, 46080
  s_mov_b32 s62, 221184
  buffer_load_dwordx4 v11, s[48:51], s62 offen lds
  s_mov_b32 m0, 47104
  s_mov_b32 s62, 245760
  buffer_load_dwordx4 v11, s[48:51], s62 offen lds
  s_mov_b32 m0, 48128
  s_mov_b32 s62, 270336
  buffer_load_dwordx4 v11, s[48:51], s62 offen lds
L_hwv2:
  s_mul_i32 s60, s3, 36864
  s_mul_i32 s61, s3, 12288
  s_add_u32 s61, s61, 65536
  s_add_u32 m0, s61, 0
  s_add_u32 s62, s60, 0
  buffer_load_dwordx4 v12, s[44:47], s62 offen lds
  s_add_u32 m0, s61, 1024
  s_add_u32 s62, s60, 3072
  buffer_load_dwordx4 v13, s[44:47], s62 offen lds
  s_add_u32 m0, s61, 2048
  s_add_u32 s62, s60, 6144
  buffer_load_dwordx4 v12, s[44:47], s62 offen lds
  s_add_u32 m0, s61, 3072
  s_add_u32 s62, s60, 9216
  buffer_load_dwordx4 v13, s[44:47], s62 offen lds
  s_add_u32 m0, s61, 4096
  s_add_u32 s62, s60, 256
  buffer_load_dwordx4 v12, s[44:47], s62 offen lds
  s_add_u32 m0, s61, 5120
  s_add_u32 s62, s60, 3328
  buffer_load_dwordx4 v13, s[44:47], s62 offen lds
  s_add_u32 m0, s61, 6144
  s_add_u32 s62, s60, 6400
  buffer_load_dwordx4 v12, s[44:47], s62 offen lds
  s_add_u32 m0, s61, 7168
  s_add_u32 s62, s60, 9472
  buffer_load_dwordx4 v13, s[44:47], s62 offen lds
  s_add_u32 m0, s61, 8192
  s_add_u32 s62, s60, 512
  buffer_load_dwordx4 v12, s[44:47], s62 offen lds
  s_add_u32 m0, s61, 9216
  s_add_u32 s62, s60, 3584
  buffer_load_dwordx4 v13, s[44:47], s62 offen lds
  s_add_u32 m0, s61, 10240
  s_add_u32 s62, s60, 6656
  buffer_load_dwordx4 v12, s[44:47], s62 offen lds
  s_add_u32 m0, s61, 11264
  s_add_u32 s62, s60, 9728
  buffer_load_dwordx4 v13, s[44:47], s62 offen lds
  s_waitcnt vmcnt(12)
  s_barrier
  ds_read_b64_tr_b16 v[160:161], v10 offset:36864
  ds_read_b64_tr_b16 v[162:163], v10 offset:36992
  ds_read_b64_tr_b16 v[164:165], v10 offset:37888
  ds_read_b64_tr_b16 v[166:167], v10 offset:38016
  ds_read_b64_tr_b16 v[168:169], v10 offset:38912
  ds_read_b64_tr_b16 v[170:171], v10 offset:39040
  ds_read_b64_tr_b16 v[172:173], v10 offset:39936
  ds_read_b64_tr_b16 v[174:175], v10 offset:40064
  ds_read_b64_tr_b16 v[176:177], v10 offset:40960
  ds_read_b64_tr_b16 v[178:179], v10 offset:41088
  ds_read_b64_tr_b16 v[180:181], v10 offset:41984
  ds_read_b64_tr_b16 v[182:183], v10 offset:42112
  ds_read_b64_tr_b16 v[184:185], v10 offset:43008
  ds_read_b64_tr_b16 v[186:187], v10 offset:43136
  s_waitcnt lgkmcnt(0)
  ds_read_b64_tr_b16 v[188:189], v10 offset:44032
  ds_read_b64_tr_b16 v[190:191], v10 offset:44160
  ds_read_b64_tr_b16 v[192:193], v10 offset:45056
  ds_read_b64_tr_b16 v[194:195], v10 offset:45184
  ds_read_b64_tr_b16 v[196:197], v10 offset:46080
  ds_read_b64_tr_b16 v[198:199], v10 offset:46208
  ds_read_b64_tr_b16 v[200:201], v10 offset:47104
  ds_read_b64_tr_b16 v[202:203], v10 offset:47232
  ds_read_b64_tr_b16 v[204:205], v10 offset:48128
  ds_read_b64_tr_b16 v[206:207], v10 offset:48256
  v_add_u32 v16, s61, v16
  v_add_u32 v17, s61, v17
  v_add_u32 v18, s61, v18
  v_add_u32 v19, s61, v19
  v_mul_u32_u24 v4, 784, v2
  v_lshl_add_u32 v4, v3, 3, v4
  s_mul_i32 s62, s3, 96
  s_add_u32 s62, s62, 49152
  v_add_u32 v7, s62, v4
  s_add_u32 s60, s60, 12288
  s_waitcnt vmcnt(8)
  ds_read_b128 v[116:119], v16 offset:0
  ds_read_b128 v[120:123], v17 offset:0
  ds_read_b128 v[124:127], v18 offset:0
  ds_read_b128 v[128:131], v19 offset:0
  s_waitcnt lgkmcnt(0)
  s_add_u32 m0, s61, 0
  s_add_u32 s62, s60, 0
  buffer_load_dwordx4 v12, s[44:47], s62 offen lds
  s_add_u32 m0, s61, 1024
  s_add_u32 s62, s60, 3072
  buffer_load_dwordx4 v13, s[44:47], s62 offen lds
  s_add_u32 m0, s61, 2048
  s_add_u32 s62, s60, 6144
  buffer_load_dwordx4 v12, s[44:47], s62 offen lds
  s_add_u32 m0, s61, 3072
  s_add_u32 s62, s60, 9216
  buffer_load_dwordx4 v13, s[44:47], s62 offen lds
  v_mfma_f32_16x16x32_bf16 v[208:211], v[116:119], v[160:163], 0
  v_mfma_f32_16x16x32_bf16 v[208:211], v[120:123], v[164:167], v[208:211]
  v_mfma_f32_16x16x32_bf16 v[208:211], v[124:127], v[168:171], v[208:211]
  v_mfma_f32_16x16x32_bf16 v[208:211], v[128:131], v[172:175], v[208:211]
  s_waitcnt vmcnt(8)
  ds_read_b128 v[116:119], v16 offset:4096
  ds_read_b128 v[120:123], v17 offset:4096
  ds_read_b128 v[124:127], v18 offset:4096
  ds_read_b128 v[128:131], v19 offset:4096
  s_waitcnt lgkmcnt(0)
  s_add_u32 m0, s61, 4096
  s_add_u32 s62, s60, 256
  buffer_load_dwordx4 v12, s[44:47], s62 offen lds
  s_add_u32 m0, s61, 5120
  s_add_u32 s62, s60, 3328
  buffer_load_dwordx4 v13, s[44:47], s62 offen lds
  s_add_u32 m0, s61, 6144
  s_add_u32 s62, s60, 6400
  buffer_load_dwordx4 v12, s[44:47], s62 offen lds
  s_add_u32 m0, s61, 7168
  s_add_u32 s62, s60, 9472
  buffer_load_dwordx4 v13, s[44:47], s62 offen lds
  v_mfma_f32_16x16x32_bf16 v[208:211], v[116:119], v[176:179], v[208:211]
  v_mfma_f32_16x16x32_bf16 v[208:211], v[120:123], v[180:183], v[208:211]
  v_mfma_f32_16x16x32_bf16 v[208:211], v[124:127], v[184:187], v[208:211]
  v_mfma_f32_16x16x32_bf16 v[208:211], v[128:131], v[188:191], v[208:211]
  s_waitcnt vmcnt(8)
  ds_read_b128 v[116:119], v16 offset:8192
  ds_read_b128 v[120:123], v17 offset:8192
  ds_read_b128 v[124:127], v18 offset:8192
  ds_read_b128 v[128:131], v19 offset:8192
  s_waitcnt lgkmcnt(0)
  s_add_u32 m0, s61, 8192
  s_add_u32 s62, s60, 512
  buffer_load_dwordx4 v12, s[44:47], s62 offen lds
  s_add_u32 m0, s61, 9216
  s_add_u32 s62, s60, 3584
  buffer_load_dwordx4 v13, s[44:47], s62 offen lds
  s_add_u32 m0, s61, 10240
  s_add_u32 s62, s60, 6656
  buffer_load_dwordx4 v12, s[44:47], s62 offen lds
  s_add_u32 m0, s61, 11264
  s_add_u32 s62, s60, 9728
  buffer_load_dwordx4 v13, s[44:47], s62 offen lds
  v_mfma_f32_16x16x32_bf16 v[208:211], v[116:119], v[192:195], v[208:211]
  v_mfma_f32_16x16x32_bf16 v[208:211], v[120:123], v[196:199], v[208:211]
  v_mfma_f32_16x16x32_bf16 v[208:211], v[124:127], v[200:203], v[208:211]
  v_mfma_f32_16x16x32_bf16 v[208:211], v[128:131], v[204:207], v[208:211]
  s_nop 7
  v_cvt_pk_bf16_f32 v212, v208, v209
  v_cvt_pk_bf16_f32 v213, v210, v211
  ds_write_b64 v7, v[212:213] offset:0
  s_add_u32 s60, s60, 12288
  s_waitcnt vmcnt(8)
  ds_read_b128 v[116:119], v16 offset:0
  ds_read_b128 v[120:123], v17 offset:0
  ds_read_b128 v[124:127], v18 offset:0
  ds_read_b128 v[128:131], v19 offset:0
  s_waitcnt lgkmcnt(0)
  s_add_u32 m0, s61, 0
  s_add_u32 s62, s60, 0
  buffer_load_dwordx4 v12, s[44:47], s62 offen lds
  s_add_u32 m0, s61, 1024
  s_add_u32 s62, s60, 3072
  buffer_load_dwordx4 v13, s[44:47], s62 offen lds
  s_add_u32 m0, s61, 2048
  s_add_u32 s62, s60, 6144
  buffer_load_dwordx4 v12, s[44:47], s62 offen lds
  s_add_u32 m0, s61, 3072
  s_add_u32 s62, s60, 9216
  buffer_load_dwordx4 v13, s[44:47], s62 offen lds
  v_mfma_f32_16x16x32_bf16 v[208:211], v[116:119], v[160:163], 0
  v_mfma_f32_16x16x32_bf16 v[208:211], v[120:123], v[164:167], v[208:211]
  v_mfma_f32_16x16x32_bf16 v[208:211], v[124:127], v[168:171], v[208:211]
  v_mfma_f32_16x16x32_bf16 v[208:211], v[128:131], v[172:175], v[208:211]
  s_waitcnt vmcnt(8)
  ds_read_b128 v[116:119], v16 offset:4096
  ds_read_b128 v[120:123], v17 offset:4096
  ds_read_b128 v[124:127], v18 offset:4096
  ds_read_b128 v[128:131], v19 offset:4096
  s_waitcnt lgkmcnt(0)
  s_add_u32 m0, s61, 4096
  s_add_u32 s62, s60, 256
  buffer_load_dwordx4 v12, s[44:47], s62 offen lds
  s_add_u32 m0, s61, 5120
  s_add_u32 s62, s60, 3328
  buffer_load_dwordx4 v13, s[44:47], s62 offen lds
  s_add_u32 m0, s61, 6144
  s_add_u32 s62, s60, 6400
  buffer_load_dwordx4 v12, s[44:47], s62 offen lds
  s_add_u32 m0, s61, 7168
  s_add_u32 s62, s60, 9472
  buffer_load_dwordx4 v13, s[44:47], s62 offen lds
  v_mfma_f32_16x16x32_bf16 v[208:211], v[116:119], v[176:179], v[208:211]
  v_mfma_f32_16x16x32_bf16 v[208:211], v[120:123], v[180:183], v[208:211]
  v_mfma_f32_16x16x32_bf16 v[208:211], v[124:127], v[184:187], v[208:211]
  v_mfma_f32_16x16x32_bf16 v[208:211], v[128:131], v[188:191], v[208:211]
  s_waitcnt vmcnt(8)
  ds_read_b128 v[116:119], v16 offset:8192
  ds_read_b128 v[120:123], v17 offset:8192
  ds_read_b128 v[124:127], v18 offset:8192
  ds_read_b128 v[128:131], v19 offset:8192
  s_waitcnt lgkmcnt(0)
  s_add_u32 m0, s61, 8192
  s_add_u32 s62, s60, 512
  buffer_load_dwordx4 v12, s[44:47], s62 offen lds
  s_add_u32 m0, s61, 9216
  s_add_u32 s62, s60, 3584
  buffer_load_dwordx4 v13, s[44:47], s62 offen lds
  s_add_u32 m0, s61, 10240
  s_add_u32 s62, s60, 6656
  buffer_load_dwordx4 v12, s[44:47], s62 offen lds
  s_add_u32 m0, s61, 11264
  s_add_u32 s62, s60, 9728
  buffer_load_dwordx4 v13, s[44:47], s62 offen lds
  v_mfma_f32_16x16x32_bf16 v[208:211], v[116:119], v[192:195], v[208:211]
  v_mfma_f32_16x16x32_bf16 v[208:211], v[120:123], v[196:199], v[208:211]
  v_mfma_f32_16x16x32_bf16 v[208:211], v[124:127], v[200:203], v[208:211]
  v_mfma_f32_16x16x32_bf16 v[208:211], v[128:131], v[204:207], v[208:211]
  s_nop 7
  v_cvt_pk_bf16_f32 v212, v208, v209
  v_cvt_pk_bf16_f32 v213, v210, v211
  ds_write_b64 v7, v[212:213] offset:32
  s_waitcnt vmcnt(8)
  ds_read_b128 v[116:119], v16 offset:0
  ds_read_b128 v[120:123], v17 offset:0
  ds_read_b128 v[124:127], v18 offset:0
  ds_read_b128 v[128:131], v19 offset:0
  s_waitcnt lgkmcnt(0)
  v_mfma_f32_16x16x32_bf16 v[208:211], v[116:119], v[160:163], 0
  v_mfma_f32_16x16x32_bf16 v[208:211], v[120:123], v[164:167], v[208:211]
  v_mfma_f32_16x16x32_bf16 v[208:211], v[124:127], v[168:171], v[208:211]
  v_mfma_f32_16x16x32_bf16 v[208:211], v[128:131], v[172:175], v[208:211]
  s_waitcnt vmcnt(4)
  ds_read_b128 v[116:119], v16 offset:4096
  ds_read_b128 v[120:123], v17 offset:4096
  ds_read_b128 v[124:127], v18 offset:4096
  ds_read_b128 v[128:131], v19 offset:4096
  s_waitcnt lgkmcnt(0)
  v_mfma_f32_16x16x32_bf16 v[208:211], v[116:119], v[176:179], v[208:211]
  v_mfma_f32_16x16x32_bf16 v[208:211], v[120:123], v[180:183], v[208:211]
  v_mfma_f32_16x16x32_bf16 v[208:211], v[124:127], v[184:187], v[208:211]
  v_mfma_f32_16x16x32_bf16 v[208:211], v[128:131], v[188:191], v[208:211]
  s_waitcnt vmcnt(0)
  ds_read_b128 v[116:119], v16 offset:8192
  ds_read_b128 v[120:123], v17 offset:8192
  ds_read_b128 v[124:127], v18 offset:8192
  ds_read_b128 v[128:131], v19 offset:8192
  s_waitcnt lgkmcnt(0)
  v_mfma_f32_16x16x32_bf16 v[208:211], v[116:119], v[192:195], v[208:211]
  v_mfma_f32_16x16x32_bf16 v[208:211], v[120:123], v[196:199], v[208:211]
  v_mfma_f32_16x16x32_bf16 v[208:211], v[124:127], v[200:203], v[208:211]
  v_mfma_f32_16x16x32_bf16 v[208:211], v[128:131], v[204:207], v[208:211]
  s_nop 7
  v_cvt_pk_bf16_f32 v212, v208, v209
  v_cvt_pk_bf16_f32 v213, v210, v211
  ds_write_b64 v7, v[212:213] offset:64
  s_waitcnt lgkmcnt(0)
  s_barrier
  s_cmp_lg_u32 s3, 0
  s_cbranch_scc1 L_hdone
  v_mul_u32_u24 v4, 784, v2
  v_lshl_add_u32 v4, v3, 4, v4
  v_add_u32 v4, 49152, v4
  ds_read_b128 v[116:119], v4 offset:0
  ds_read_b128 v[120:123], v4 offset:64
  ds_read_b128 v[124:127], v4 offset:128
  ds_read_b128 v[128:131], v4 offset:192
  ds_read_b128 v[132:135], v4 offset:256
  ds_read_b128 v[136:139], v4 offset:320
  ds_read_b128 v[140:143], v4 offset:384
  ds_read_b128 v[144:147], v4 offset:448
  ds_read_b128 v[148:151], v4 offset:512
  ds_read_b128 v[152:155], v4 offset:576
  ds_read_b128 v[156:159], v4 offset:640
  ds_read_b128 v[160:163], v4 offset:704
  v_mul_u32_u24 v7, 768, v2
  v_lshl_add_u32 v7, v3, 3, v7
  s_lshl_b32 s61, s56, 5
  buffer_load_dwordx2 v[20:21], v7, s[24:27], s61 offen
  s_waitcnt vmcnt(0) lgkmcnt(0)
  v_lshlrev_b32 v24, 16, v20
  v_and_b32 v25, 0xffff0000, v20
  v_lshlrev_b32 v26, 16, v21
  v_and_b32 v27, 0xffff0000, v21
  v_mul_u32_u24 v6, 768, v2
  v_lshl_add_u32 v6, v3, 4, v6
  s_mov_b32 s62, 36864
  s_mov_b32 s71, 0
L_c1_33:
  buffer_load_dword v68, v6, s[32:35], s62 offen sc1
  s_add_u32 s71, s71, 1
  s_cmp_gt_u32 s71, 200000
  s_cbranch_scc1 L_c1d_34
  s_waitcnt vmcnt(0)
  v_cmp_ne_u32 vcc, -1, v68
  s_cbranch_vccnz L_c1d_34
  s_sleep 6
  s_branch L_c1_33
L_c1d_34:
  s_waitcnt vmcnt(0)
  s_sleep 16
  s_add_u32 s63, s62, 4096
  s_add_u32 s64, s62, 8192
  s_mov_b32 s71, 0
L_c_35:
  buffer_load_dwordx4 v[68:71], v6, s[32:35], s62 offen offset:0 sc1
  buffer_load_dwordx4 v[72:75], v6, s[32:35], s62 offen offset:64 sc1
  buffer_load_dwordx4 v[76:79], v6, s[32:35], s62 offen offset:128 sc1
  buffer_load_dwordx4 v[80:83], v6, s[32:35], s62 offen offset:192 sc1
  buffer_load_dwordx4 v[84:87], v6, s[32:35], s62 offen offset:256 sc1
  buffer_load_dwordx4 v[88:91], v6, s[32:35], s62 offen offset:320 sc1
  buffer_load_dwordx4 v[92:95], v6, s[32:35], s62 offen offset:384 sc1
  buffer_load_dwordx4 v[96:99], v6, s[32:35], s62 offen offset:448 sc1
  buffer_load_dwordx4 v[100:103], v6, s[32:35], s62 offen offset:512 sc1
  buffer_load_dwordx4 v[104:107], v6, s[32:35], s62 offen offset:576 sc1
  buffer_load_dwordx4 v[108:111], v6, s[32:35], s62 offen offset:640 sc1
  buffer_load_dwordx4 v[112:115], v6, s[32:35], s62 offen offset:704 sc1
  s_add_u32 s71, s71, 1
  s_cmp_gt_u32 s71, 200000
  s_cbranch_scc1 L_cd_36
  s_waitcnt vmcnt(0)
  v_max3_u32 v4, v68, v69, v70
  v_max3_u32 v5, v92, v93, v94
  v_max3_u32 v4, v4, v71, v72
  v_max3_u32 v5, v5, v95, v96
  v_max3_u32 v4, v4, v73, v74
  v_max3_u32 v5, v5, v97, v98
  v_max3_u32 v4, v4, v75, v76
  v_max3_u32 v5, v5, v99, v100
  v_max3_u32 v4, v4, v77, v78
  v_max3_u32 v5, v5, v101, v102
  v_max3_u32 v4, v4, v79, v80
  v_max3_u32 v5, v5, v103, v104
  v_max3_u32 v4, v4, v81, v82
  v_max3_u32 v5, v5, v105, v106
  v_max3_u32 v4, v4, v83, v84
  v_max3_u32 v5, v5, v107, v108
  v_max3_u32 v4, v4, v85, v86
  v_max3_u32 v5, v5, v109, v110
  v_max3_u32 v4, v4, v87, v88
  v_max3_u32 v5, v5, v111, v112
  v_max3_u32 v4, v4, v89, v90
  v_max3_u32 v5, v5, v113, v114
  v_max_u32 v4, v4, v91
  v_max_u32 v5, v5, v115
  v_max_u32 v4, v4, v5
  v_cmp_eq_u32 vcc, -1, v4
  s_cbranch_vccnz L_c_35
L_cd_36:
  s_waitcnt vmcnt(0)
  v_mfma_f32_16x16x32_bf16 v[208:211], v[116:119], v[68:71], v[24:27]
  v_mfma_f32_16x16x32_bf16 v[212:215], v[120:123], v[72:75], 0
  v_mfma_f32_16x16x32_bf16 v[208:211], v[124:127], v[76:79], v[208:211]
  v_mfma_f32_16x16x32_bf16 v[212:215], v[128:131], v[80:83], v[212:215]
  v_mfma_f32_16x16x32_bf16 v[208:211], v[132:135], v[84:87], v[208:211]
  v_mfma_f32_16x16x32_bf16 v[212:215], v[136:139], v[88:91], v[212:215]
  v_mfma_f32_16x16x32_bf16 v[208:211], v[140:143], v[92:95], v[208:211]
  v_mfma_f32_16x16x32_bf16 v[212:215], v[144:147], v[96:99], v[212:215]
  v_mfma_f32_16x16x32_bf16 v[208:211], v[148:151], v[100:103], v[208:211]
  v_mfma_f32_16x16x32_bf16 v[212:215], v[152:155], v[104:107], v[212:215]
  v_mfma_f32_16x16x32_bf16 v[208:211], v[156:159], v[108:111], v[208:211]
  v_mfma_f32_16x16x32_bf16 v[212:215], v[160:163], v[112:115], v[212:215]
  s_nop 7
  v_pk_add_f32 v[208:209], v[208:209], v[212:213]
  v_pk_add_f32 v[210:211], v[210:211], v[214:215]
  v_cvt_pk_bf16_f32 v212, v208, v209
  v_cvt_pk_bf16_f32 v213, v210, v211
  buffer_store_dwordx2 v[212:213], v7, s[52:55], s61 offen
  s_cmp_lg_u32 s56, 0
  s_cbranch_scc1 L_nononce_38
  buffer_store_dword v15, v14, s[32:35], 0 offen offset:0 sc1
L_nononce_38:
L_hdone:
  s_endpgm
L_collect:
  s_cmp_lg_u32 s3, 0
  s_cbranch_scc1 L_end
  s_waitcnt lgkmcnt(0)
  s_mov_b32 s32, s22
  s_mov_b32 s33, s23
  s_mov_b32 s34, 268435456
  s_mov_b32 s35, 0x20000
  v_mov_b32 v2, 0
  buffer_load_dword v3, v2, s[32:35], 0 offen offset:0 sc1
  v_min_u32 v4, 23, v0
  v_lshlrev_b32 v4, 7, v4
  v_add_u32 v4, 49152, v4
  s_waitcnt vmcnt(0)
  v_add_u32 v3, 1, v3
  s_nop 0
  v_readfirstlane_b32 s70, v3
  s_mov_b32 s71, 0
L_flg_39:
  buffer_load_dword v5, v4, s[32:35], 0 offen sc1
  s_add_u32 s71, s71, 1
  s_cmp_gt_u32 s71, 200000
  s_cbranch_scc1 L_flgd_41
L_flgc_40:
  s_waitcnt vmcnt(0)
  v_cmp_ne_u32 vcc, s70, v5
  s_cbranch_vccnz L_flg_39
L_flgd_41:
  s_waitcnt vmcnt(0)
  s_mov_b32 s62, 53248
  s_mov_b64 exec, 1
  buffer_store_dword v3, v2, s[32:35], s62 offen sc1
  s_endpgm
L_end:
  s_endpgm
L_code_end:
.section .rodata,"a"
.p2align 6
.amdhsa_kernel standalone__detection_seg_dino__vision_kernel
  .amdhsa_next_free_vgpr 256
  .amdhsa_next_free_sgpr 102
  .amdhsa_accum_offset 256
  .amdhsa_group_segment_fixed_size 0
  .amdhsa_kernarg_size 80
  .amdhsa_user_sgpr_count 2
  .amdhsa_user_sgpr_kernarg_segment_ptr 1
  .amdhsa_system_sgpr_workgroup_id_x 1
  .amdhsa_float_denorm_mode_32 3
.end_amdhsa_kernel
```
